```python
import torch

def _softmax(x, axis=-1):
    return torch.softmax(x, dim=axis)

def _gelu(x):
    return torch.nn.functional.gelu(x, approximate='tanh')

def _silu(x):
    return torch.nn.functional.silu(x)

def _sigmoid(x):
    return torch.sigmoid(x)

def _layernorm(x, axis=-1, eps=1e-05):
    m = x.mean(dim=axis, keepdim=True)
    v = x.var(dim=axis, keepdim=True, unbiased=False)
    return (x - m) / torch.sqrt(v + eps)

def _scatter_add(tgt, idx, src, axis=0):
    return tgt.clone().index_add_(axis, idx, src)

def _segment_sum(src, seg, n):
    out = torch.zeros((n,) + src.shape[1:], dtype=src.dtype)
    return out.index_add_(0, seg, src)

def _pad(x, pw):
    flat = tuple((v for pair in reversed(pw) for v in pair))
    return torch.nn.functional.pad(x, flat)
kernel_name = 'adaLN_cond__compressed_kv_cla__mixer_channel_mlp__decode'

def setup_inputs():

    _w = lambda a: (lambda t: t.to(torch.bfloat16) if t.is_floating_point() else t)(torch.as_tensor(a))

    def _A_setup():
        B, H, Sq, Sk, D, M = (1, 32, 1, 4096, 128, 512)
        Dc = 4 * D
        return {'x': _w((lambda *s: torch.randn(*s, dtype=torch.bfloat16) * 0.1)(B, Sq, M)), 'c_kv': _w((lambda *s: torch.randn(*s, dtype=torch.bfloat16) * 0.8)(B, Sk, Dc)), 'w_q': _w((lambda *s: torch.randn(*s, dtype=torch.bfloat16) * 0.8)(M, H, D) * M ** (-0.5)), 'w_uk': _w((lambda *s: torch.randn(*s, dtype=torch.bfloat16) * 0.8)(Dc, H, D) * Dc ** (-0.5)), 'w_uv': _w((lambda *s: torch.randn(*s, dtype=torch.bfloat16) * 0.8)(Dc, H, D) * Dc ** (-0.5)), 'w_o': _w((lambda *s: torch.randn(*s, dtype=torch.bfloat16) * 0.8)(H, D, M) * (H * D) ** (-0.5))}
    _A_in = _A_setup()

    def _B_setup():
        B, S, D, F = (1, 1, 512, 1376)
        return {'x': _w((lambda *s: torch.randn(*s, dtype=torch.bfloat16) * 0.1)(B, S, D)), 'w1': _w((lambda *s: torch.randn(*s, dtype=torch.bfloat16) * 3.2)(D, F) * D ** (-0.5)), 'b1': _w((lambda *s: torch.randn(*s, dtype=torch.bfloat16) * 3.2)(F)), 'w2': _w((lambda *s: torch.randn(*s, dtype=torch.bfloat16) * 3.2)(F, D) * F ** (-0.5)), 'b2': _w((lambda *s: torch.randn(*s, dtype=torch.bfloat16) * 3.2)(D))}
    _B_in = _B_setup()
    return {'A_x': _A_in['x'], 'A_c_kv': _A_in['c_kv'], 'A_w_q': _A_in['w_q'], 'A_w_uk': _A_in['w_uk'], 'A_w_uv': _A_in['w_uv'], 'A_w_o': _A_in['w_o'], 'B_x': _B_in['x'], 'B_w1': _B_in['w1'], 'B_b1': _B_in['b1'], 'B_w2': _B_in['w2'], 'B_b2': _B_in['b2'], 'c': _w((lambda *s: torch.randn(*s, dtype=torch.bfloat16) * 0.4)(1, 512) * 8.0), 'w_mod': _w((lambda *s: torch.randn(*s, dtype=torch.bfloat16) * 0.4)(512, 6 * 512) * 512 ** (-0.5) * 8.0)}

def reference(A_x, A_c_kv, A_w_q, A_w_uk, A_w_uv, A_w_o, B_x, B_w1, B_b1, B_w2, B_b2, c, w_mod):

    def _A_ref(x, c_kv, w_q, w_uk, w_uv, w_o):
        B, Sq, M = (x.shape[0], x.shape[1], x.shape[2])
        Sk = c_kv.shape[1]
        H, D = (w_q.shape[1], w_q.shape[2])
        q = torch.einsum('bqm,mhd->bhqd', x, w_q)
        k = torch.einsum('bkc,chd->bhkd', c_kv, w_uk)
        v = torch.einsum('bkc,chd->bhkd', c_kv, w_uv)
        scores = torch.einsum('bhqd,bhkd->bhqk', q, k) * D ** (-0.5)
        off = Sk - Sq
        qi = torch.arange(Sq)[:, None]
        kj = torch.arange(Sk)[None, :]
        cmask = kj <= qi + off
        scores = torch.where(cmask[None, None], scores, -1000000000.0)
        p = _softmax(scores, axis=-1)
        ctx = torch.einsum('bhqk,bhkd->bhqd', p, v)
        return torch.einsum('bhqd,hdm->bqm', ctx, w_o)

    def _B_ref(x, w1, b1, w2, b2):
        y = _layernorm(x, axis=-1)
        h = _gelu(torch.einsum('bsd,df->bsf', y, w1) + b1)
        return torch.einsum('bsf,fd->bsd', h, w2) + b2
    x = A_x
    mod = (_silu(c) @ w_mod).reshape(c.shape[0], 6, 1, -1)
    sa, ca, ga, sb, cb, gb = (mod[:, 0].clone(), mod[:, 1].clone(), mod[:, 2].clone(), mod[:, 3].clone(), mod[:, 4].clone(), mod[:, 5].clone())
    h = _layernorm(x, axis=-1) * (1 + ca) + sa
    x = x + ga * _A_ref(h, A_c_kv, A_w_q, A_w_uk, A_w_uv, A_w_o)
    h = _layernorm(x, axis=-1) * (1 + cb) + sb
    x = x + gb * _B_ref(h, B_w1, B_b1, B_w2, B_b2)
    return x
```

```asm
; @launch grid=(256,1,1) block=(640,1,1) lds=92160
.amdgcn_target "amdgcn-amd-amdhsa--gfx950"
.text
.globl adaLN_cond__compressed_kv_cla__mixer_channel_mlp__decode_kernel
.p2align 8
.type adaLN_cond__compressed_kv_cla__mixer_channel_mlp__decode_kernel,@function
adaLN_cond__compressed_kv_cla__mixer_channel_mlp__decode_kernel:
    s_cmp_ge_u32 s2, 256
    s_cbranch_scc1 K_END
    s_load_dwordx16 s[40:55], s[0:1], 0
    s_load_dwordx16 s[56:71], s[0:1], 64
    v_lshrrev_b32 v1, 6, v0
    v_lshrrev_b32 v4, 3, v0
    v_readfirstlane_b32 s39, v1
    v_and_b32 v5, 7, v0
    s_lshr_b32 s30, s2, 3
    s_and_b32 s31, s2, 7
    s_and_b32 s32, s2, 3
    s_lshr_b32 s33, s2, 2
    s_cmp_ge_u32 s39, 8
    s_cbranch_scc1 AUX
    s_lshl_b32 s3, s32, 7
    v_add_u32 v6, s3, v4
    v_lshlrev_b32 v7, 1, v6
    v_mul_u32_u24 v8, 0x1800, v6
    v_lshl_add_u32 v8, v5, 4, v8
    s_lshl_b32 s3, s33, 7
    v_add_u32 v8, s3, v8
    s_mov_b32 s34, 393216
    v_lshlrev_b32 v9, 13, v6
    v_lshl_add_u32 v9, v5, 4, v9
    s_lshl_b32 s3, s30, 8
    s_bfe_u32 s28, s2, 0x10002
    s_lshl_b32 s28, s28, 7
    s_add_u32 s3, s3, s28
    v_add_u32 v9, s3, v9
    s_mov_b32 s35, 0x80000
    v_lshlrev_b32 v10, 13, v4
    v_lshl_add_u32 v10, v5, 5, v10
    s_lshl_b32 s3, s31, 19
    s_lshl_b32 s28, s30, 8
    s_add_u32 s74, s3, s28
    v_lshlrev_b32 v12, 1, v0
    s_lshl_b32 s3, s39, 8
    v_lshlrev_b32 v123, 5, v5
    v_add_u32 v123, s3, v123
    v_bfe_u32 v2, v0, 4, 1
    v_lshl_add_u32 v123, v2, 3, v123
    v_bfe_u32 v2, v0, 5, 1
    v_lshl_add_u32 v123, v2, 4, v123
    s_and_b32 s77, s2, 63
    s_lshr_b32 s78, s2, 6
    v_and_b32 v1, 63, v0
    v_lshrrev_b32 v2, 3, v1
    v_and_b32 v3, 7, v1
    v_xor_b32 v3, v3, v2
    v_lshlrev_b32 v3, 4, v3
    v_lshl_add_u32 v119, v2, 10, v3
    s_lshl_b32 s3, s39, 7
    s_lshl_b32 s29, s77, 16
    s_add_u32 s29, s29, s3
    s_mul_i32 s79, s39, 8192
    s_add_u32 s79, s79, 16384
    s_sub_u32 s76, s2, 213
    s_waitcnt lgkmcnt(0)
    s_mov_b32 s4, s70
    s_mov_b32 s5, s71
    s_mov_b32 s6, 6291456
    s_mov_b32 s7, 0x20000
    s_mov_b32 s12, s40
    s_mov_b32 s13, s41
    s_mov_b32 s14, 1024
    s_mov_b32 s15, 0x20000
    s_mov_b32 s16, s64
    s_mov_b32 s17, s65
    s_mov_b32 s18, 3145728
    s_mov_b32 s19, 0x20000
    s_mov_b32 s20, s62
    s_mov_b32 s21, s63
    s_mov_b32 s22, 1024
    s_mov_b32 s23, 0x20000
    s_cmp_lt_u32 s2, 192
    s_cbranch_scc1 C_MLD
    s_cmp_ge_u32 s2, 208
    s_cbranch_scc1 C_NOM
    s_mov_b32 s8, s68
    s_mov_b32 s9, s69
    s_mov_b32 s10, 256
    s_mov_b32 s11, 0x20000
    s_sub_u32 s28, s2, 192
    v_lshlrev_b32 v1, 4, v0
    v_mov_b32 v16, -1
    v_mov_b32 v17, -1
    v_mov_b32 v18, -1
    v_mov_b32 v19, -1
    v_mov_b32 v20, 1
    v_mov_b32 v21, 0
    s_lshl_b32 s3, s28, 13
    s_cmp_ge_u32 s28, 6
    s_cbranch_scc1 C_INIT2
    buffer_store_dwordx4 v[16:19], v1, s[4:7], s3 offen sc1
    s_waitcnt vmcnt(0)
    s_barrier
    v_cmp_eq_u32 vcc, 0, v0
    s_and_saveexec_b64 s[36:37], vcc
    s_lshl_b32 s24, s28, 2
    buffer_store_dword v20, v21, s[8:11], s24 offen offset:128 sc1
    s_mov_b64 exec, s[36:37]
C_INIT2:
    s_lshl_b32 s3, s28, 15
    s_add_u32 s3, s3, 0x10000
    buffer_store_dwordx4 v[16:19], v1, s[4:7], s3 offen sc1
    s_add_u32 s3, s3, 8192
    buffer_store_dwordx4 v[16:19], v1, s[4:7], s3 offen sc1
    s_add_u32 s3, s3, 8192
    buffer_store_dwordx4 v[16:19], v1, s[4:7], s3 offen sc1
    s_add_u32 s3, s3, 8192
    buffer_store_dwordx4 v[16:19], v1, s[4:7], s3 offen sc1
    s_waitcnt vmcnt(0)
    s_barrier
    v_cmp_eq_u32 vcc, 0, v0
    s_and_saveexec_b64 s[36:37], vcc
    buffer_atomic_add v20, v21, s[8:11], 0 offen
    s_mov_b64 exec, s[36:37]
    s_branch C_NOM
C_MLD:
    buffer_load_ushort v24, v7, s[20:23], 0 offen
    buffer_load_ushort v25, v7, s[20:23], 0 offen offset:128
    buffer_load_dwordx4 v[32:35], v8, s[16:19], 0 offen
    buffer_load_dwordx4 v[36:39], v8, s[16:19], s34 offen
C_NOM:
    s_mov_b32 s16, s44
    s_mov_b32 s17, s45
    s_mov_b32 s18, 4194304
    s_mov_b32 s19, 0x20000
    s_mov_b32 s20, s46
    s_mov_b32 s21, s47
    s_mov_b32 s22, 4194304
    s_mov_b32 s23, 0x20000
    s_mov_b32 s96, s42
    s_mov_b32 s97, s43
    s_mov_b32 s98, 4194304
    s_mov_b32 s99, 0x20000
    s_cmp_lt_u32 s2, 192
    s_cbranch_scc1 C_NOWQ
    s_mov_b32 s16, s44
    s_mov_b32 s17, s45
    s_mov_b32 s18, 4194304
    s_mov_b32 s19, 0x20000
    buffer_load_dwordx4 v[72:75], v9, s[16:19], 0 offen
    buffer_load_dwordx4 v[76:79], v9, s[16:19], s35 offen
    s_mov_b32 s20, s46
    s_mov_b32 s21, s47
    s_mov_b32 s22, 4194304
    s_mov_b32 s23, 0x20000
    buffer_load_dwordx4 v[80:83], v10, s[20:23], s74 offen
    buffer_load_dwordx4 v[84:87], v10, s[20:23], s74 offen offset:16
C_NOWQ:
    buffer_load_ushort v120, v12, s[12:15], 0 offen
    s_mov_b32 s16, s60
    s_mov_b32 s17, s61
    s_mov_b32 s18, 1024
    s_mov_b32 s19, 0x20000
    buffer_load_ushort v122, v12, s[16:19], 0 offen
    s_cmp_lt_u32 s2, 213
    s_cbranch_scc1 C_NOG
    s_mov_b32 s16, s54
    s_mov_b32 s17, s55
    s_mov_b32 s18, 1409024
    s_mov_b32 s19, 0x20000
    v_lshrrev_b32 v6, 2, v0
    v_mul_u32_u24 v6, 2752, v6
    v_and_b32 v15, 3, v0
    v_lshl_add_u32 v6, v15, 4, v6
    s_lshl_b32 s28, s76, 6
    s_add_u32 s3, s28, 0
    buffer_load_dwordx4 v[128:131], v6, s[16:19], s3 offen
    s_add_u32 s3, s28, 352256
    buffer_load_dwordx4 v[132:135], v6, s[16:19], s3 offen
    s_add_u32 s3, s28, 704512
    buffer_load_dwordx4 v[136:139], v6, s[16:19], s3 offen
    s_add_u32 s3, s28, 1056768
    buffer_load_dwordx4 v[140:143], v6, s[16:19], s3 offen
    s_mov_b32 s16, s56
    s_mov_b32 s17, s57
    s_mov_b32 s18, 2752
    s_mov_b32 s19, 0x20000
    v_and_b32 v6, 31, v0
    v_lshlrev_b32 v6, 1, v6
    buffer_load_ushort v121, v6, s[16:19], s28 offen
    s_waitcnt vmcnt(7)
C_NOG:
    s_cmp_ge_u32 s2, 192
    s_cbranch_scc1 C_M_DONE
    s_waitcnt vmcnt(4)
    v_lshlrev_b32 v24, 16, v24
    v_mul_f32 v28, 0xbfb8aa3b, v24
    v_lshlrev_b32 v25, 16, v25
    v_mul_f32 v29, 0xbfb8aa3b, v25
    v_exp_f32 v28, v28
    v_exp_f32 v29, v29
    s_nop 0
    v_add_f32 v28, 1.0, v28
    v_add_f32 v29, 1.0, v29
    v_rcp_f32 v28, v28
    v_rcp_f32 v29, v29
    s_nop 0
    v_mul_f32 v24, v24, v28
    v_mul_f32 v25, v25, v29
    v_cvt_pk_bf16_f32 v28, v24, v25
    v_lshlrev_b32 v24, 16, v28
    v_and_b32 v25, 0xffff0000, v28
    s_waitcnt vmcnt(2)
    s_mov_b32 s16, s44
    s_mov_b32 s17, s45
    s_mov_b32 s18, 4194304
    s_mov_b32 s19, 0x20000
    buffer_load_dwordx4 v[72:75], v9, s[16:19], 0 offen
    buffer_load_dwordx4 v[76:79], v9, s[16:19], s35 offen
    v_lshlrev_b32 v42, 16, v32
    v_and_b32 v43, 0xffff0000, v32
    v_mul_f32 v48, v24, v42
    v_mul_f32 v49, v24, v43
    v_lshlrev_b32 v42, 16, v33
    v_and_b32 v43, 0xffff0000, v33
    v_mul_f32 v50, v24, v42
    v_mul_f32 v51, v24, v43
    v_lshlrev_b32 v42, 16, v34
    v_and_b32 v43, 0xffff0000, v34
    v_mul_f32 v52, v24, v42
    v_mul_f32 v53, v24, v43
    v_lshlrev_b32 v42, 16, v35
    v_and_b32 v43, 0xffff0000, v35
    v_mul_f32 v54, v24, v42
    v_mul_f32 v55, v24, v43
    v_lshlrev_b32 v42, 16, v36
    v_and_b32 v43, 0xffff0000, v36
    v_fmac_f32 v48, v25, v42
    v_fmac_f32 v49, v25, v43
    v_lshlrev_b32 v42, 16, v37
    v_and_b32 v43, 0xffff0000, v37
    v_fmac_f32 v50, v25, v42
    v_fmac_f32 v51, v25, v43
    v_lshlrev_b32 v42, 16, v38
    v_and_b32 v43, 0xffff0000, v38
    v_fmac_f32 v52, v25, v42
    v_fmac_f32 v53, v25, v43
    v_lshlrev_b32 v42, 16, v39
    v_and_b32 v43, 0xffff0000, v39
    v_fmac_f32 v54, v25, v42
    v_fmac_f32 v55, v25, v43
    s_nop 1
    v_permlane32_swap_b32 v48, v52
    v_permlane32_swap_b32 v49, v53
    v_permlane32_swap_b32 v50, v54
    v_permlane32_swap_b32 v51, v55
    s_nop 0
    v_add_f32 v48, v48, v52
    v_add_f32 v49, v49, v53
    v_add_f32 v50, v50, v54
    v_add_f32 v51, v51, v55
    s_nop 0
    v_permlane16_swap_b32 v48, v50
    v_permlane16_swap_b32 v49, v51
    s_nop 0
    v_add_f32 v48, v48, v50
    v_add_f32 v49, v49, v51
    s_nop 1
    v_add_f32_dpp v48, v48, v48 row_ror:8 row_mask:0xf bank_mask:0xf
    v_add_f32_dpp v49, v49, v49 row_ror:8 row_mask:0xf bank_mask:0xf
    ds_write_b64 v123, v[48:49] offset:0
    s_waitcnt lgkmcnt(0)
C_M_DONE:
    s_barrier
    s_barrier
    s_cmp_ge_u32 s2, 192
    s_cbranch_scc1 C_NOWQ2
    s_mov_b32 s20, s46
    s_mov_b32 s21, s47
    s_mov_b32 s22, 4194304
    s_mov_b32 s23, 0x20000
    buffer_load_dwordx4 v[80:83], v10, s[20:23], s74 offen
    buffer_load_dwordx4 v[84:87], v10, s[20:23], s74 offen offset:16
    s_nop 0
C_NOWQ2:
    s_add_u32 m0, s79, 0
    s_add_u32 s3, s29, 0
    buffer_load_dwordx4 v119, s[96:99], s3 offen lds
    s_add_u32 m0, s79, 1024
    s_add_u32 s3, s29, 8192
    buffer_load_dwordx4 v119, s[96:99], s3 offen lds
    s_add_u32 m0, s79, 2048
    s_add_u32 s3, s29, 16384
    buffer_load_dwordx4 v119, s[96:99], s3 offen lds
    s_add_u32 m0, s79, 3072
    s_add_u32 s3, s29, 24576
    buffer_load_dwordx4 v119, s[96:99], s3 offen lds
    s_cmp_ge_u32 s2, 213
    s_cbranch_scc1 CW1
    s_waitcnt vmcnt(6)
CW1:
    v_lshlrev_b32 v3, 2, v4
    s_barrier
    ds_read_b32 v40, v3 offset:4096
    ds_read_b32 v41, v3 offset:4352
    s_waitcnt lgkmcnt(0)
    v_lshlrev_b32 v42, 16, v72
    v_and_b32 v43, 0xffff0000, v72
    v_mul_f32 v48, v40, v42
    v_mul_f32 v49, v40, v43
    v_lshlrev_b32 v42, 16, v73
    v_and_b32 v43, 0xffff0000, v73
    v_mul_f32 v50, v40, v42
    v_mul_f32 v51, v40, v43
    v_lshlrev_b32 v42, 16, v74
    v_and_b32 v43, 0xffff0000, v74
    v_mul_f32 v52, v40, v42
    v_mul_f32 v53, v40, v43
    v_lshlrev_b32 v42, 16, v75
    v_and_b32 v43, 0xffff0000, v75
    v_mul_f32 v54, v40, v42
    v_mul_f32 v55, v40, v43
    v_lshlrev_b32 v42, 16, v76
    v_and_b32 v43, 0xffff0000, v76
    v_fmac_f32 v48, v41, v42
    v_fmac_f32 v49, v41, v43
    v_lshlrev_b32 v42, 16, v77
    v_and_b32 v43, 0xffff0000, v77
    v_fmac_f32 v50, v41, v42
    v_fmac_f32 v51, v41, v43
    v_lshlrev_b32 v42, 16, v78
    v_and_b32 v43, 0xffff0000, v78
    v_fmac_f32 v52, v41, v42
    v_fmac_f32 v53, v41, v43
    v_lshlrev_b32 v42, 16, v79
    v_and_b32 v43, 0xffff0000, v79
    v_fmac_f32 v54, v41, v42
    v_fmac_f32 v55, v41, v43
    s_nop 1
    v_permlane32_swap_b32 v48, v52
    v_permlane32_swap_b32 v49, v53
    v_permlane32_swap_b32 v50, v54
    v_permlane32_swap_b32 v51, v55
    s_nop 0
    v_add_f32 v48, v48, v52
    v_add_f32 v49, v49, v53
    v_add_f32 v50, v50, v54
    v_add_f32 v51, v51, v55
    s_nop 0
    v_permlane16_swap_b32 v48, v50
    v_permlane16_swap_b32 v49, v51
    s_nop 0
    v_add_f32 v48, v48, v50
    v_add_f32 v49, v49, v51
    s_nop 1
    v_add_f32_dpp v48, v48, v48 row_ror:8 row_mask:0xf bank_mask:0xf
    v_add_f32_dpp v49, v49, v49 row_ror:8 row_mask:0xf bank_mask:0xf
    ds_write_b64 v123, v[48:49] offset:2048
    s_waitcnt lgkmcnt(0)
    s_barrier
    s_barrier
    s_add_u32 m0, s79, 4096
    s_add_u32 s3, s29, 32768
    buffer_load_dwordx4 v119, s[96:99], s3 offen lds
    s_add_u32 m0, s79, 5120
    s_add_u32 s3, s29, 40960
    buffer_load_dwordx4 v119, s[96:99], s3 offen lds
    s_add_u32 m0, s79, 6144
    s_add_u32 s3, s29, 49152
    buffer_load_dwordx4 v119, s[96:99], s3 offen lds
    s_add_u32 m0, s79, 7168
    s_add_u32 s3, s29, 57344
    buffer_load_dwordx4 v119, s[96:99], s3 offen lds
    s_cmp_ge_u32 s2, 213
    s_cbranch_scc1 CW2
    s_waitcnt vmcnt(8)
CW2:
    v_lshlrev_b32 v1, 6, v5
    s_barrier
    ds_read_b128 v[16:19], v1 offset:4608
    ds_read_b128 v[20:23], v1 offset:4624
    ds_read_b128 v[24:27], v1 offset:4640
    ds_read_b128 v[28:31], v1 offset:4656
    s_waitcnt lgkmcnt(0)
    v_lshlrev_b32 v42, 16, v80
    v_and_b32 v43, 0xffff0000, v80
    v_mul_f32 v48, v16, v42
    v_mul_f32 v49, v17, v43
    v_lshlrev_b32 v42, 16, v81
    v_and_b32 v43, 0xffff0000, v81
    v_fmac_f32 v48, v18, v42
    v_fmac_f32 v49, v19, v43
    v_lshlrev_b32 v42, 16, v82
    v_and_b32 v43, 0xffff0000, v82
    v_fmac_f32 v48, v20, v42
    v_fmac_f32 v49, v21, v43
    v_lshlrev_b32 v42, 16, v83
    v_and_b32 v43, 0xffff0000, v83
    v_fmac_f32 v48, v22, v42
    v_fmac_f32 v49, v23, v43
    v_lshlrev_b32 v42, 16, v84
    v_and_b32 v43, 0xffff0000, v84
    v_fmac_f32 v48, v24, v42
    v_fmac_f32 v49, v25, v43
    v_lshlrev_b32 v42, 16, v85
    v_and_b32 v43, 0xffff0000, v85
    v_fmac_f32 v48, v26, v42
    v_fmac_f32 v49, v27, v43
    v_lshlrev_b32 v42, 16, v86
    v_and_b32 v43, 0xffff0000, v86
    v_fmac_f32 v48, v28, v42
    v_fmac_f32 v49, v29, v43
    v_lshlrev_b32 v42, 16, v87
    v_and_b32 v43, 0xffff0000, v87
    v_fmac_f32 v48, v30, v42
    v_fmac_f32 v49, v31, v43
    v_add_f32 v48, v48, v49
    s_nop 1
    v_add_f32_dpp v48, v48, v48 quad_perm:[1,0,3,2] row_mask:0xf bank_mask:0xf
    s_nop 1
    v_add_f32_dpp v48, v48, v48 quad_perm:[2,3,0,1] row_mask:0xf bank_mask:0xf
    s_nop 1
    v_add_f32_dpp v48, v48, v48 row_half_mirror row_mask:0xf bank_mask:0xf
    v_cvt_pk_bf16_f32 v49, v48, v48
    v_and_b32 v50, 0xffff0000, v49
    v_sub_f32 v48, v48, v50
    v_cvt_pk_bf16_f32 v48, v48, v48
    v_and_b32 v49, 0xffff, v49
    v_lshl_or_b32 v48, v48, 16, v49
    v_lshlrev_b32 v1, 2, v4
    s_lshl_b32 s3, s2, 8
    s_add_u32 s3, s3, 131072
    v_cmp_eq_u32 vcc, 0, v5
    s_and_saveexec_b64 s[36:37], vcc
    buffer_store_dword v48, v1, s[4:7], s3 offen sc1
    s_mov_b64 exec, s[36:37]
    s_barrier
    s_mov_b32 s16, s48
    s_mov_b32 s17, s49
    s_mov_b32 s18, 4194304
    s_mov_b32 s19, 0x20000
    s_mov_b32 s20, s50
    s_mov_b32 s21, s51
    s_mov_b32 s22, 4194304
    s_mov_b32 s23, 0x20000
    v_lshrrev_b32 v4, 3, v0
    v_and_b32 v5, 7, v0
    v_lshlrev_b32 v10, 13, v4
    v_lshl_add_u32 v10, v5, 5, v10
    buffer_load_dwordx4 v[88:91], v10, s[16:19], s74 offen
    buffer_load_dwordx4 v[92:95], v10, s[16:19], s74 offen offset:16
    v_and_b32 v1, 63, v0
    v_lshrrev_b32 v2, 4, v1
    v_and_b32 v3, 15, v1
    v_min_u32 v6, 7, v3
    v_lshlrev_b32 v6, 11, v6
    v_lshl_add_u32 v6, v2, 5, v6
    s_lshl_b32 s24, s78, 14
    s_lshl_b32 s26, s39, 8
    s_add_u32 s24, s24, s26
    s_add_u32 s24, s24, 131072
    v_and_b32 v7, 7, v3
    v_xor_b32 v7, v7, v2
    v_lshlrev_b32 v7, 4, v7
    v_lshl_add_u32 v7, v3, 7, v7
    v_add_u32 v7, s79, v7
    v_xor_b32 v8, 64, v7
    v_and_b32 v9, 7, v3
    v_lshl_add_u32 v11, v2, 3, v9
    v_lshlrev_b32 v11, 4, v11
    s_lshl_b32 s3, s39, 11
    v_add_u32 v12, s3, v11
    v_lshrrev_b32 v13, 2, v3
    v_lshl_add_u32 v13, v2, 2, v13
    v_and_b32 v116, 7, v13
    v_bfe_u32 v9, v1, 1, 1
    v_xor_b32 v116, v116, v9
    v_lshlrev_b32 v116, 4, v116
    v_lshl_add_u32 v116, v13, 7, v116
    v_and_b32 v9, 1, v1
    v_lshl_add_u32 v116, v9, 3, v116
    v_add_u32 v116, s79, v116
    v_lshlrev_b32 v117, 7, v3
    v_lshl_add_u32 v117, v2, 3, v117
    v_add_u32 v117, s79, v117
    v_lshlrev_b32 v118, 4, v1
    v_add_u32 v118, s79, v118
    v_lshrrev_b32 v115, 3, v1
    v_lshlrev_b32 v115, 16, v115
    v_and_b32 v13, 7, v1
    v_lshl_add_u32 v115, v13, 4, v115
    s_lshl_b32 s72, s78, 19
    s_lshl_b32 s26, s77, 10
    s_add_u32 s72, s72, s26
    s_lshl_b32 s26, s39, 7
    s_add_u32 s72, s72, s26
    s_add_u32 s72, s72, 1048576
    s_lshl_b32 s73, s78, 12
    s_lshl_b32 s26, s77, 3
    s_add_u32 s73, s73, s26
    s_add_u32 s73, s73, 196608
    v_lshlrev_b32 v114, 9, v3
    s_mov_b32 s25, 0x05040100
    s_mov_b32 s26, 0x07060302
    s_mov_b32 s38, 0
GA1:
    buffer_load_dwordx4 v[16:19], v6, s[4:7], s24 offen offset:0 sc1
    buffer_load_dwordx4 v[20:23], v6, s[4:7], s24 offen offset:16 sc1
    buffer_load_dwordx4 v[24:27], v6, s[4:7], s24 offen offset:128 sc1
    buffer_load_dwordx4 v[28:31], v6, s[4:7], s24 offen offset:144 sc1
    s_add_u32 s38, s38, 1
    s_waitcnt vmcnt(0)
    v_max3_u32 v70, v16, v17, v18
    v_max3_u32 v70, v70, v19, v20
    v_max3_u32 v70, v70, v21, v22
    v_max3_u32 v70, v70, v23, v24
    v_max3_u32 v70, v70, v25, v26
    v_max3_u32 v70, v70, v27, v28
    v_max3_u32 v70, v70, v29, v30
    v_max_u32 v70, v70, v31
    v_cmp_eq_u32 vcc, -1, v70
    s_cmp_gt_u32 s38, 0x40000
    s_cbranch_scc1 GD2
    s_nop 2
    s_cmp_eq_u64 vcc, 0
    s_cbranch_scc1 GD2
    s_sleep 1
    s_branch GA1
GD2:
    v_mov_b32 v14, v11
    v_mov_b32 v11, v14
    v_perm_b32 v32, v17, v16, s25
    v_perm_b32 v40, v17, v16, s26
    v_perm_b32 v33, v19, v18, s25
    v_perm_b32 v41, v19, v18, s26
    v_perm_b32 v34, v21, v20, s25
    v_perm_b32 v42, v21, v20, s26
    v_perm_b32 v35, v23, v22, s25
    v_perm_b32 v43, v23, v22, s26
    v_perm_b32 v36, v25, v24, s25
    v_perm_b32 v44, v25, v24, s26
    v_perm_b32 v37, v27, v26, s25
    v_perm_b32 v45, v27, v26, s26
    v_perm_b32 v38, v29, v28, s25
    v_perm_b32 v46, v29, v28, s26
    v_perm_b32 v39, v31, v30, s25
    v_perm_b32 v47, v31, v30, s26
    ds_read_b128 v[16:19], v7 offset:0
    ds_read_b128 v[20:23], v8 offset:0
    s_waitcnt lgkmcnt(1)
    v_mfma_f32_16x16x32_bf16 v[56:59], v[16:19], v[32:35], 0
    v_mfma_f32_16x16x32_bf16 v[56:59], v[16:19], v[40:43], v[56:59]
    s_waitcnt lgkmcnt(0)
    v_mfma_f32_16x16x32_bf16 v[56:59], v[20:23], v[36:39], v[56:59]
    v_mfma_f32_16x16x32_bf16 v[56:59], v[20:23], v[44:47], v[56:59]
    ds_read_b128 v[24:27], v7 offset:2048
    ds_read_b128 v[28:31], v8 offset:2048
    s_waitcnt lgkmcnt(1)
    v_mfma_f32_16x16x32_bf16 v[60:63], v[24:27], v[32:35], 0
    v_mfma_f32_16x16x32_bf16 v[60:63], v[24:27], v[40:43], v[60:63]
    s_waitcnt lgkmcnt(0)
    v_mfma_f32_16x16x32_bf16 v[60:63], v[28:31], v[36:39], v[60:63]
    v_mfma_f32_16x16x32_bf16 v[60:63], v[28:31], v[44:47], v[60:63]
    ds_read_b128 v[16:19], v7 offset:4096
    ds_read_b128 v[20:23], v8 offset:4096
    s_waitcnt lgkmcnt(1)
    v_mfma_f32_16x16x32_bf16 v[64:67], v[16:19], v[32:35], 0
    v_mfma_f32_16x16x32_bf16 v[64:67], v[16:19], v[40:43], v[64:67]
    s_waitcnt lgkmcnt(0)
    v_mfma_f32_16x16x32_bf16 v[64:67], v[20:23], v[36:39], v[64:67]
    v_mfma_f32_16x16x32_bf16 v[64:67], v[20:23], v[44:47], v[64:67]
    ds_read_b128 v[24:27], v7 offset:6144
    ds_read_b128 v[28:31], v8 offset:6144
    s_waitcnt lgkmcnt(1)
    v_mfma_f32_16x16x32_bf16 v[68:71], v[24:27], v[32:35], 0
    v_mfma_f32_16x16x32_bf16 v[68:71], v[24:27], v[40:43], v[68:71]
    s_waitcnt lgkmcnt(0)
    v_mfma_f32_16x16x32_bf16 v[68:71], v[28:31], v[36:39], v[68:71]
    v_mfma_f32_16x16x32_bf16 v[68:71], v[28:31], v[44:47], v[68:71]
    v_cmp_gt_u32 vcc, 8, v3
    s_and_saveexec_b64 s[36:37], vcc
    s_nop 6
    ds_write_b128 v12, v[56:59] offset:0
    ds_write_b128 v12, v[60:63] offset:512
    ds_write_b128 v12, v[64:67] offset:1024
    ds_write_b128 v12, v[68:71] offset:1536
    s_mov_b64 exec, s[36:37]
    s_waitcnt lgkmcnt(0)
    s_barrier
    s_lshr_b32 s3, s39, 1
    s_lshl_b32 s3, s3, 9
    s_and_b32 s28, s39, 1
    s_lshl_b32 s28, s28, 3
    s_add_u32 s3, s3, s28
    v_add_u32 v12, s3, v11
    ds_read_b64 v[16:17], v12 offset:0
    ds_read_b64 v[18:19], v12 offset:2048
    ds_read_b64 v[20:21], v12 offset:4096
    ds_read_b64 v[22:23], v12 offset:6144
    ds_read_b64 v[24:25], v12 offset:8192
    ds_read_b64 v[26:27], v12 offset:10240
    ds_read_b64 v[28:29], v12 offset:12288
    ds_read_b64 v[30:31], v12 offset:14336
    v_add_u32 v12, 90112, v12
    v_add_u32 v11, 90112, v11
    s_waitcnt lgkmcnt(0)
    v_add_f32 v16, v16, v18
    v_add_f32 v20, v20, v22
    v_add_f32 v24, v24, v26
    v_add_f32 v28, v28, v30
    v_add_f32 v16, v16, v20
    v_add_f32 v24, v24, v28
    v_add_f32 v16, v16, v24
    v_add_f32 v17, v17, v19
    v_add_f32 v21, v21, v23
    v_add_f32 v25, v25, v27
    v_add_f32 v29, v29, v31
    v_add_f32 v17, v17, v21
    v_add_f32 v25, v25, v29
    v_add_f32 v17, v17, v25
    v_cvt_pk_bf16_f32 v18, v16, v17
    v_lshlrev_b32 v16, 16, v18
    v_and_b32 v17, 0xffff0000, v18
    v_mul_f32 v16, 0x3db504f3, v16
    v_mul_f32 v17, 0x3db504f3, v17
    v_cvt_pk_bf16_f32 v18, v16, v17
    v_lshlrev_b32 v16, 16, v18
    v_and_b32 v17, 0xffff0000, v18
    ds_write_b64 v12, v[16:17]
    s_waitcnt lgkmcnt(0)
    s_barrier
    ds_read_b128 v[16:19], v11 offset:0
    ds_read_b128 v[20:23], v11 offset:512
    ds_read_b128 v[24:27], v11 offset:1024
    ds_read_b128 v[28:31], v11 offset:1536
    s_waitcnt lgkmcnt(0)
    v_max_f32 v32, v16, v17
    v_max3_f32 v32, v32, v18, v19
    v_max3_f32 v32, v32, v20, v21
    v_max3_f32 v32, v32, v22, v23
    v_max3_f32 v32, v32, v24, v25
    v_max3_f32 v32, v32, v26, v27
    v_max3_f32 v32, v32, v28, v29
    v_max3_f32 v32, v32, v30, v31
    v_mov_b32 v33, v32
    s_nop 1
    v_permlane16_swap_b32 v32, v33
    s_nop 1
    v_max_f32 v32, v32, v33
    v_mov_b32 v33, v32
    s_nop 1
    v_permlane32_swap_b32 v32, v33
    s_nop 1
    v_max_f32 v32, v32, v33
    s_mov_b32 s3, 0x3fb8aa3b
    v_mul_f32 v33, s3, v32
    v_fma_f32 v16, v16, s3, -v33
    v_fma_f32 v17, v17, s3, -v33
    v_fma_f32 v18, v18, s3, -v33
    v_fma_f32 v19, v19, s3, -v33
    v_fma_f32 v20, v20, s3, -v33
    v_fma_f32 v21, v21, s3, -v33
    v_fma_f32 v22, v22, s3, -v33
    v_fma_f32 v23, v23, s3, -v33
    v_fma_f32 v24, v24, s3, -v33
    v_fma_f32 v25, v25, s3, -v33
    v_fma_f32 v26, v26, s3, -v33
    v_fma_f32 v27, v27, s3, -v33
    v_fma_f32 v28, v28, s3, -v33
    v_fma_f32 v29, v29, s3, -v33
    v_fma_f32 v30, v30, s3, -v33
    v_fma_f32 v31, v31, s3, -v33
    v_exp_f32 v16, v16
    v_exp_f32 v17, v17
    v_exp_f32 v18, v18
    v_exp_f32 v19, v19
    v_exp_f32 v20, v20
    v_exp_f32 v21, v21
    v_exp_f32 v22, v22
    v_exp_f32 v23, v23
    v_exp_f32 v24, v24
    v_exp_f32 v25, v25
    v_exp_f32 v26, v26
    v_exp_f32 v27, v27
    v_exp_f32 v28, v28
    v_exp_f32 v29, v29
    v_exp_f32 v30, v30
    v_exp_f32 v31, v31
    v_cvt_pk_bf16_f32 v40, v16, v17
    v_cvt_pk_bf16_f32 v41, v18, v19
    v_cvt_pk_bf16_f32 v42, v20, v21
    v_cvt_pk_bf16_f32 v43, v22, v23
    v_cvt_pk_bf16_f32 v44, v24, v25
    v_cvt_pk_bf16_f32 v45, v26, v27
    v_cvt_pk_bf16_f32 v46, v28, v29
    v_cvt_pk_bf16_f32 v47, v30, v31
    v_xor_b32 v13, 0, v116
    ds_read_b64_tr_b16 v[72:73], v13 offset:0
    ds_read_b64_tr_b16 v[74:75], v13 offset:2048
    ds_read_b64_tr_b16 v[76:77], v13 offset:4096
    ds_read_b64_tr_b16 v[78:79], v13 offset:6144
    v_xor_b32 v13, 32, v116
    ds_read_b64_tr_b16 v[80:81], v13 offset:0
    ds_read_b64_tr_b16 v[82:83], v13 offset:2048
    ds_read_b64_tr_b16 v[84:85], v13 offset:4096
    ds_read_b64_tr_b16 v[86:87], v13 offset:6144
    v_xor_b32 v13, 64, v116
    ds_read_b64_tr_b16 v[48:49], v13 offset:0
    ds_read_b64_tr_b16 v[50:51], v13 offset:2048
    ds_read_b64_tr_b16 v[52:53], v13 offset:4096
    ds_read_b64_tr_b16 v[54:55], v13 offset:6144
    v_add_f32 v34, v16, v17
    v_add_f32 v34, v34, v18
    v_add_f32 v34, v34, v19
    v_add_f32 v34, v34, v20
    v_add_f32 v34, v34, v21
    v_add_f32 v34, v34, v22
    v_add_f32 v34, v34, v23
    v_add_f32 v34, v34, v24
    v_add_f32 v34, v34, v25
    v_add_f32 v34, v34, v26
    v_add_f32 v34, v34, v27
    v_add_f32 v34, v34, v28
    v_add_f32 v34, v34, v29
    v_add_f32 v34, v34, v30
    v_add_f32 v34, v34, v31
    v_xor_b32 v13, 96, v116
    ds_read_b64_tr_b16 v[16:17], v13 offset:0
    ds_read_b64_tr_b16 v[18:19], v13 offset:2048
    ds_read_b64_tr_b16 v[20:21], v13 offset:4096
    ds_read_b64_tr_b16 v[22:23], v13 offset:6144
    v_mov_b32 v33, v34
    s_nop 1
    v_permlane16_swap_b32 v34, v33
    s_nop 1
    v_add_f32 v34, v34, v33
    v_mov_b32 v33, v34
    s_nop 1
    v_permlane32_swap_b32 v34, v33
    s_nop 1
    v_add_f32 v34, v34, v33
    s_waitcnt lgkmcnt(14)
    v_mfma_f32_16x16x32_bf16 v[56:59], v[72:75], v[40:43], 0
    s_waitcnt lgkmcnt(12)
    v_mfma_f32_16x16x32_bf16 v[56:59], v[76:79], v[44:47], v[56:59]
    s_waitcnt lgkmcnt(10)
    v_mfma_f32_16x16x32_bf16 v[60:63], v[80:83], v[40:43], 0
    s_waitcnt lgkmcnt(8)
    v_mfma_f32_16x16x32_bf16 v[60:63], v[84:87], v[44:47], v[60:63]
    s_waitcnt lgkmcnt(6)
    v_mfma_f32_16x16x32_bf16 v[64:67], v[48:51], v[40:43], 0
    s_waitcnt lgkmcnt(4)
    v_mfma_f32_16x16x32_bf16 v[64:67], v[52:55], v[44:47], v[64:67]
    s_waitcnt lgkmcnt(2)
    v_mfma_f32_16x16x32_bf16 v[68:71], v[16:19], v[40:43], 0
    s_waitcnt lgkmcnt(0)
    v_mfma_f32_16x16x32_bf16 v[68:71], v[20:23], v[44:47], v[68:71]
    v_mov_b32 v35, v34
    v_mov_b32 v34, v32
    v_cmp_gt_u32 vcc, 8, v3
    s_and_saveexec_b64 s[36:37], vcc
    s_nop 3
    v_cvt_pk_bf16_f32 v16, v56, v57
    v_cvt_pk_bf16_f32 v17, v58, v59
    ds_write_b64 v117, v[16:17] offset:0
    v_cvt_pk_bf16_f32 v18, v60, v61
    v_cvt_pk_bf16_f32 v19, v62, v63
    ds_write_b64 v117, v[18:19] offset:32
    v_cvt_pk_bf16_f32 v20, v64, v65
    v_cvt_pk_bf16_f32 v21, v66, v67
    ds_write_b64 v117, v[20:21] offset:64
    v_cvt_pk_bf16_f32 v22, v68, v69
    v_cvt_pk_bf16_f32 v23, v70, v71
    ds_write_b64 v117, v[22:23] offset:96
    s_mov_b64 exec, s[36:37]
    s_waitcnt lgkmcnt(0)
    ds_read_b128 v[16:19], v118
    s_waitcnt lgkmcnt(0)
    buffer_store_dwordx4 v[16:19], v115, s[4:7], s72 offen sc1
    v_cmp_gt_u32 vcc, 8, v0
    s_and_saveexec_b64 s[36:37], vcc
    buffer_store_dwordx2 v[34:35], v114, s[4:7], s73 offen sc1
    s_mov_b64 exec, s[36:37]
    s_barrier
    s_lshr_b32 s3, s2, 5
    s_lshl_b32 s3, s3, 19
    s_and_b32 s28, s2, 7
    s_lshl_b32 s28, s28, 7
    s_add_u32 s3, s3, s28
    s_bfe_u32 s28, s2, 0x20003
    s_lshl_b32 s28, s28, 5
    s_add_u32 s3, s3, s28
    v_lshrrev_b32 v11, 1, v0
    v_lshlrev_b32 v11, 10, v11
    v_and_b32 v15, 1, v0
    v_lshl_add_u32 v11, v15, 4, v11
    s_add_u32 s28, s3, 0x40000
    buffer_load_dwordx4 v[96:99], v11, s[20:23], s3 offen
    buffer_load_dwordx4 v[100:103], v11, s[20:23], s28 offen
    v_lshrrev_b32 v4, 3, v0
    v_and_b32 v5, 7, v0
    v_lshlrev_b32 v6, 10, v4
    v_lshl_add_u32 v6, v5, 4, v6
    s_lshl_b32 s24, s30, 16
    s_lshl_b32 s26, s31, 7
    s_add_u32 s24, s24, s26
    s_add_u32 s24, s24, 1048576
    v_and_b32 v1, 63, v0
    v_lshlrev_b32 v7, 3, v1
    s_lshl_b32 s25, s30, 9
    s_add_u32 s25, s25, 196608
    s_mov_b32 s38, 0
GA4:
    buffer_load_dwordx2 v[40:41], v7, s[4:7], s25 offen sc1
    buffer_load_dwordx4 v[16:19], v6, s[4:7], s24 offen sc1
    s_add_u32 s38, s38, 1
    s_waitcnt vmcnt(0)
    v_max3_u32 v70, v40, v41, v16
    v_max3_u32 v70, v70, v17, v18
    v_max_u32 v70, v70, v19
    v_cmp_eq_u32 vcc, -1, v70
    s_cmp_gt_u32 s38, 0x40000
    s_cbranch_scc1 GD5
    s_nop 2
    s_cmp_eq_u64 vcc, 0
    s_cbranch_scc1 GD5
    s_sleep 1
    s_branch GA4
GD5:
    s_cmp_lt_u32 s2, 213
    s_cbranch_scc1 C_NOG2
    s_mov_b32 s16, s58
    s_mov_b32 s17, s59
    s_mov_b32 s18, 1409024
    s_mov_b32 s19, 0x20000
    v_and_b32 v6, 255, v0
    v_lshlrev_b32 v6, 2, v6
    s_lshl_b32 s3, s76, 15
    s_lshr_b32 s28, s39, 2
    s_lshl_b32 s28, s28, 14
    s_add_u32 s3, s3, s28
    buffer_load_dword v144, v6, s[16:19], s3 offen offset:0
    buffer_load_dword v145, v6, s[16:19], s3 offen offset:1024
    buffer_load_dword v146, v6, s[16:19], s3 offen offset:2048
    buffer_load_dword v147, v6, s[16:19], s3 offen offset:3072
    s_add_u32 s3, s3, 4096
    buffer_load_dword v148, v6, s[16:19], s3 offen offset:0
    buffer_load_dword v149, v6, s[16:19], s3 offen offset:1024
    buffer_load_dword v150, v6, s[16:19], s3 offen offset:2048
    buffer_load_dword v151, v6, s[16:19], s3 offen offset:3072
    s_add_u32 s3, s3, 4096
    buffer_load_dword v152, v6, s[16:19], s3 offen offset:0
    buffer_load_dword v153, v6, s[16:19], s3 offen offset:1024
    buffer_load_dword v154, v6, s[16:19], s3 offen offset:2048
    buffer_load_dword v155, v6, s[16:19], s3 offen offset:3072
    s_add_u32 s3, s3, 4096
    buffer_load_dword v156, v6, s[16:19], s3 offen offset:0
    buffer_load_dword v157, v6, s[16:19], s3 offen offset:1024
    buffer_load_dword v158, v6, s[16:19], s3 offen offset:2048
    buffer_load_dword v159, v6, s[16:19], s3 offen offset:3072
C_NOG2:
    v_mov_b32 v42, v40
    s_nop 1
    v_max_f32_dpp v42, v42, v42 row_ror:8 row_mask:0xf bank_mask:0xf
    s_nop 1
    v_max_f32_dpp v42, v42, v42 row_ror:4 row_mask:0xf bank_mask:0xf
    s_nop 1
    v_max_f32_dpp v42, v42, v42 row_ror:2 row_mask:0xf bank_mask:0xf
    s_nop 1
    v_max_f32_dpp v42, v42, v42 row_ror:1 row_mask:0xf bank_mask:0xf
    v_mov_b32 v43, v42
    s_nop 1
    v_permlane16_swap_b32 v42, v43
    s_nop 0
    v_max_f32 v42, v42, v43
    v_mov_b32 v43, v42
    s_nop 1
    v_permlane32_swap_b32 v42, v43
    s_nop 0
    v_max_f32 v42, v42, v43
    v_sub_f32 v40, v40, v42
    v_mul_f32 v40, 0x3fb8aa3b, v40
    v_exp_f32 v40, v40
    s_nop 0
    v_mul_f32 v41, v41, v40
    s_nop 1
    v_add_f32_dpp v41, v41, v41 row_ror:8 row_mask:0xf bank_mask:0xf
    s_nop 1
    v_add_f32_dpp v41, v41, v41 row_ror:4 row_mask:0xf bank_mask:0xf
    s_nop 1
    v_add_f32_dpp v41, v41, v41 row_ror:2 row_mask:0xf bank_mask:0xf
    s_nop 1
    v_add_f32_dpp v41, v41, v41 row_ror:1 row_mask:0xf bank_mask:0xf
    v_mov_b32 v43, v41
    s_nop 1
    v_permlane16_swap_b32 v41, v43
    s_nop 0
    v_add_f32 v41, v41, v43
    v_mov_b32 v43, v41
    s_nop 1
    v_permlane32_swap_b32 v41, v43
    s_nop 0
    v_add_f32 v41, v41, v43
    v_rcp_f32 v41, v41
    v_lshlrev_b32 v42, 2, v4
    v_mul_f32 v40, v40, v41
    s_nop 0
    ds_bpermute_b32 v40, v42, v40
    s_waitcnt lgkmcnt(0)
    v_lshlrev_b32 v42, 16, v16
    v_and_b32 v43, 0xffff0000, v16
    v_mul_f32 v48, v40, v42
    v_mul_f32 v49, v40, v43
    v_lshlrev_b32 v42, 16, v17
    v_and_b32 v43, 0xffff0000, v17
    v_mul_f32 v50, v40, v42
    v_mul_f32 v51, v40, v43
    v_lshlrev_b32 v42, 16, v18
    v_and_b32 v43, 0xffff0000, v18
    v_mul_f32 v52, v40, v42
    v_mul_f32 v53, v40, v43
    v_lshlrev_b32 v42, 16, v19
    v_and_b32 v43, 0xffff0000, v19
    v_mul_f32 v54, v40, v42
    v_mul_f32 v55, v40, v43
    s_nop 1
    v_permlane32_swap_b32 v48, v52
    v_permlane32_swap_b32 v49, v53
    v_permlane32_swap_b32 v50, v54
    v_permlane32_swap_b32 v51, v55
    s_nop 0
    v_add_f32 v48, v48, v52
    v_add_f32 v49, v49, v53
    v_add_f32 v50, v50, v54
    v_add_f32 v51, v51, v55
    s_nop 0
    v_permlane16_swap_b32 v48, v50
    v_permlane16_swap_b32 v49, v51
    s_nop 0
    v_add_f32 v48, v48, v50
    v_add_f32 v49, v49, v51
    s_nop 1
    v_add_f32_dpp v48, v48, v48 row_ror:8 row_mask:0xf bank_mask:0xf
    v_add_f32_dpp v49, v49, v49 row_ror:8 row_mask:0xf bank_mask:0xf
    ds_write_b64 v123, v[48:49] offset:0
    s_waitcnt lgkmcnt(0)
    v_lshlrev_b32 v3, 2, v4
    s_barrier
    ds_read_b32 v8, v3 offset:0
    ds_read_b32 v9, v3 offset:256
    ds_read_b32 v10, v3 offset:512
    ds_read_b32 v11, v3 offset:768
    ds_read_b32 v12, v3 offset:1024
    ds_read_b32 v13, v3 offset:1280
    ds_read_b32 v14, v3 offset:1536
    ds_read_b32 v15, v3 offset:1792
    s_waitcnt lgkmcnt(0)
    v_add_f32 v8, v8, v9
    v_add_f32 v10, v10, v11
    v_add_f32 v12, v12, v13
    v_add_f32 v14, v14, v15
    v_add_f32 v8, v8, v10
    v_add_f32 v12, v12, v14
    v_add_f32 v8, v8, v12
    v_mov_b32 v40, v8
    v_lshlrev_b32 v42, 16, v88
    v_and_b32 v43, 0xffff0000, v88
    v_mul_f32 v16, v40, v42
    v_mul_f32 v17, v40, v43
    v_lshlrev_b32 v42, 16, v89
    v_and_b32 v43, 0xffff0000, v89
    v_mul_f32 v18, v40, v42
    v_mul_f32 v19, v40, v43
    v_lshlrev_b32 v42, 16, v90
    v_and_b32 v43, 0xffff0000, v90
    v_mul_f32 v20, v40, v42
    v_mul_f32 v21, v40, v43
    v_lshlrev_b32 v42, 16, v91
    v_and_b32 v43, 0xffff0000, v91
    v_mul_f32 v22, v40, v42
    v_mul_f32 v23, v40, v43
    v_lshlrev_b32 v42, 16, v92
    v_and_b32 v43, 0xffff0000, v92
    v_mul_f32 v24, v40, v42
    v_mul_f32 v25, v40, v43
    v_lshlrev_b32 v42, 16, v93
    v_and_b32 v43, 0xffff0000, v93
    v_mul_f32 v26, v40, v42
    v_mul_f32 v27, v40, v43
    v_lshlrev_b32 v42, 16, v94
    v_and_b32 v43, 0xffff0000, v94
    v_mul_f32 v28, v40, v42
    v_mul_f32 v29, v40, v43
    v_lshlrev_b32 v42, 16, v95
    v_and_b32 v43, 0xffff0000, v95
    v_mul_f32 v30, v40, v42
    v_mul_f32 v31, v40, v43
    s_nop 1
    v_permlane32_swap_b32 v16, v24
    v_permlane32_swap_b32 v17, v25
    v_permlane32_swap_b32 v18, v26
    v_permlane32_swap_b32 v19, v27
    v_permlane32_swap_b32 v20, v28
    v_permlane32_swap_b32 v21, v29
    v_permlane32_swap_b32 v22, v30
    v_permlane32_swap_b32 v23, v31
    s_nop 0
    v_add_f32 v16, v16, v24
    v_add_f32 v17, v17, v25
    v_add_f32 v18, v18, v26
    v_add_f32 v19, v19, v27
    v_add_f32 v20, v20, v28
    v_add_f32 v21, v21, v29
    v_add_f32 v22, v22, v30
    v_add_f32 v23, v23, v31
    s_nop 0
    v_permlane16_swap_b32 v16, v20
    v_permlane16_swap_b32 v17, v21
    v_permlane16_swap_b32 v18, v22
    v_permlane16_swap_b32 v19, v23
    s_nop 0
    v_add_f32 v16, v16, v20
    v_add_f32 v17, v17, v21
    v_add_f32 v18, v18, v22
    v_add_f32 v19, v19, v23
    v_add_f32_dpp v16, v16, v16 row_ror:8 row_mask:0xf bank_mask:0xf
    v_add_f32_dpp v17, v17, v17 row_ror:8 row_mask:0xf bank_mask:0xf
    v_add_f32_dpp v18, v18, v18 row_ror:8 row_mask:0xf bank_mask:0xf
    v_add_f32_dpp v19, v19, v19 row_ror:8 row_mask:0xf bank_mask:0xf
    s_lshl_b32 s3, s39, 9
    v_lshlrev_b32 v1, 6, v5
    v_add_u32 v1, s3, v1
    v_bfe_u32 v2, v0, 4, 2
    v_lshl_add_u32 v1, v2, 4, v1
    ds_write_b128 v1, v[16:19] offset:4096
    s_waitcnt lgkmcnt(0)
    s_barrier
    v_lshrrev_b32 v1, 7, v0
    v_lshlrev_b32 v1, 12, v1
    v_and_b32 v2, 127, v0
    v_lshl_add_u32 v1, v2, 2, v1
    s_lshr_b32 s3, s2, 5
    s_lshl_b32 s3, s3, 14
    s_add_u32 s3, s3, 262144
    s_mov_b32 s38, 0
GA7:
    buffer_load_dword v16, v1, s[4:7], s3 offen offset:0 sc1
    buffer_load_dword v17, v1, s[4:7], s3 offen offset:512 sc1
    buffer_load_dword v18, v1, s[4:7], s3 offen offset:1024 sc1
    buffer_load_dword v19, v1, s[4:7], s3 offen offset:1536 sc1
    buffer_load_dword v20, v1, s[4:7], s3 offen offset:2048 sc1
    buffer_load_dword v21, v1, s[4:7], s3 offen offset:2560 sc1
    buffer_load_dword v22, v1, s[4:7], s3 offen offset:3072 sc1
    buffer_load_dword v23, v1, s[4:7], s3 offen offset:3584 sc1
    s_add_u32 s38, s38, 1
    s_waitcnt vmcnt(0)
    v_max3_u32 v70, v16, v17, v18
    v_max3_u32 v70, v70, v19, v20
    v_max3_u32 v70, v70, v21, v22
    v_max_u32 v70, v70, v23
    v_cmp_eq_u32 vcc, -1, v70
    s_cmp_gt_u32 s38, 0x40000
    s_cbranch_scc1 GD8
    s_nop 2
    s_cmp_eq_u64 vcc, 0
    s_cbranch_scc1 GD8
    s_sleep 1
    s_branch GA7
GD8:
    v_add_f32 v16, v16, v17
    v_add_f32 v18, v18, v19
    v_add_f32 v20, v20, v21
    v_add_f32 v22, v22, v23
    v_add_f32 v16, v16, v18
    v_add_f32 v20, v20, v22
    v_add_f32 v16, v16, v20
    v_cvt_pk_bf16_f32 v16, v16, v16
    v_lshlrev_b32 v16, 16, v16
    v_lshlrev_b32 v1, 2, v0
    ds_write_b32 v1, v16 offset:8192
    v_lshrrev_b32 v3, 1, v0
    v_lshlrev_b32 v3, 2, v3
    s_waitcnt lgkmcnt(0)
    s_barrier
    ds_read_b32 v40, v3 offset:8192
    ds_read_b32 v41, v3 offset:9216
    s_waitcnt lgkmcnt(0)
    v_lshlrev_b32 v42, 16, v96
    v_and_b32 v43, 0xffff0000, v96
    v_mul_f32 v48, v40, v42
    v_mul_f32 v49, v40, v43
    v_lshlrev_b32 v42, 16, v97
    v_and_b32 v43, 0xffff0000, v97
    v_mul_f32 v50, v40, v42
    v_mul_f32 v51, v40, v43
    v_lshlrev_b32 v42, 16, v98
    v_and_b32 v43, 0xffff0000, v98
    v_mul_f32 v52, v40, v42
    v_mul_f32 v53, v40, v43
    v_lshlrev_b32 v42, 16, v99
    v_and_b32 v43, 0xffff0000, v99
    v_mul_f32 v54, v40, v42
    v_mul_f32 v55, v40, v43
    v_lshlrev_b32 v42, 16, v100
    v_and_b32 v43, 0xffff0000, v100
    v_fmac_f32 v48, v41, v42
    v_fmac_f32 v49, v41, v43
    v_lshlrev_b32 v42, 16, v101
    v_and_b32 v43, 0xffff0000, v101
    v_fmac_f32 v50, v41, v42
    v_fmac_f32 v51, v41, v43
    v_lshlrev_b32 v42, 16, v102
    v_and_b32 v43, 0xffff0000, v102
    v_fmac_f32 v52, v41, v42
    v_fmac_f32 v53, v41, v43
    v_lshlrev_b32 v42, 16, v103
    v_and_b32 v43, 0xffff0000, v103
    v_fmac_f32 v54, v41, v42
    v_fmac_f32 v55, v41, v43
    s_nop 1
    v_permlane32_swap_b32 v48, v52
    v_permlane32_swap_b32 v49, v53
    v_permlane32_swap_b32 v50, v54
    v_permlane32_swap_b32 v51, v55
    s_nop 0
    v_add_f32 v48, v48, v52
    v_add_f32 v49, v49, v53
    v_add_f32 v50, v50, v54
    v_add_f32 v51, v51, v55
    s_nop 0
    v_permlane16_swap_b32 v48, v50
    v_permlane16_swap_b32 v49, v51
    s_nop 0
    v_add_f32 v48, v48, v50
    v_add_f32 v49, v49, v51
    s_nop 1
    v_add_f32_dpp v48, v48, v48 row_ror:8 row_mask:0xf bank_mask:0xf
    v_add_f32_dpp v49, v49, v49 row_ror:8 row_mask:0xf bank_mask:0xf
    s_nop 1
    v_add_f32_dpp v48, v48, v48 row_ror:4 row_mask:0xf bank_mask:0xf
    v_add_f32_dpp v49, v49, v49 row_ror:4 row_mask:0xf bank_mask:0xf
    s_nop 1
    v_add_f32_dpp v48, v48, v48 row_ror:2 row_mask:0xf bank_mask:0xf
    v_add_f32_dpp v49, v49, v49 row_ror:2 row_mask:0xf bank_mask:0xf
    s_lshl_b32 s3, s39, 6
    v_and_b32 v5, 1, v0
    v_lshlrev_b32 v3, 5, v5
    v_add_u32 v3, s3, v3
    v_bfe_u32 v5, v0, 4, 1
    v_lshl_add_u32 v3, v5, 3, v3
    v_bfe_u32 v5, v0, 5, 1
    v_lshl_add_u32 v3, v5, 4, v3
    ds_write_b64 v3, v[48:49] offset:12288
    s_waitcnt lgkmcnt(0)
    s_barrier
    s_cmp_lt_u32 s2, 205
    s_cbranch_scc1 K_TS
    v_lshlrev_b32 v1, 4, v0
    v_add_u32 v1, 81920, v1
    ds_read_b128 v[124:127], v1
    s_cmp_lt_u32 s2, 213
    s_cbranch_scc1 H_GO
    v_lshlrev_b32 v1, 2, v0
    s_mov_b32 s3, 393216
    s_add_u32 s24, s3, 4096
    s_add_u32 s25, s3, 8192
    s_add_u32 s26, s3, 12288
    s_mov_b32 s38, 0
GA10:
    buffer_load_dword v16, v1, s[4:7], s3 offen offset:0 sc1
    buffer_load_dword v17, v1, s[4:7], s3 offen offset:2048 sc1
    buffer_load_dword v18, v1, s[4:7], s24 offen offset:0 sc1
    buffer_load_dword v19, v1, s[4:7], s24 offen offset:2048 sc1
    buffer_load_dword v20, v1, s[4:7], s25 offen offset:0 sc1
    buffer_load_dword v21, v1, s[4:7], s25 offen offset:2048 sc1
    buffer_load_dword v22, v1, s[4:7], s26 offen offset:0 sc1
    buffer_load_dword v23, v1, s[4:7], s26 offen offset:2048 sc1
    s_add_u32 s38, s38, 1
    s_waitcnt vmcnt(0)
    v_max3_u32 v70, v16, v17, v18
    v_max3_u32 v70, v70, v19, v20
    v_max3_u32 v70, v70, v21, v22
    v_max_u32 v70, v70, v23
    v_cmp_eq_u32 vcc, -1, v70
    s_cmp_gt_u32 s38, 0x40000
    s_cbranch_scc1 GD11
    s_nop 2
    s_cmp_eq_u64 vcc, 0
    s_cbranch_scc1 GD11
    s_sleep 1
    s_branch GA10
GD11:
    v_add_f32 v16, v16, v17
    v_add_f32 v18, v18, v19
    v_add_f32 v20, v20, v21
    v_add_f32 v22, v22, v23
    v_add_f32 v16, v16, v18
    v_add_f32 v20, v20, v22
    v_add_f32 v16, v16, v20
    v_cvt_pk_bf16_f32 v16, v16, v16
    v_lshlrev_b32 v16, 16, v16
    s_waitcnt lgkmcnt(0)
    v_mul_f32 v16, v16, v124
    v_cvt_pk_bf16_f32 v16, v16, v16
    v_lshlrev_b32 v16, 16, v16
    v_lshlrev_b32 v17, 16, v120
    v_add_f32 v16, v16, v17
    v_cvt_pk_bf16_f32 v16, v16, v16
    v_lshlrev_b32 v16, 16, v16
    s_lshl_b32 s3, s39, 3
    v_mov_b32 v3, s3
    v_mov_b32 v2, 0
    v_mov_b32 v44, v16
    v_mul_f32 v45, v16, v16
    s_nop 1
    v_add_f32_dpp v44, v44, v44 row_ror:8 row_mask:0xf bank_mask:0xf
    v_add_f32_dpp v45, v45, v45 row_ror:8 row_mask:0xf bank_mask:0xf
    s_nop 1
    v_add_f32_dpp v44, v44, v44 row_ror:4 row_mask:0xf bank_mask:0xf
    v_add_f32_dpp v45, v45, v45 row_ror:4 row_mask:0xf bank_mask:0xf
    s_nop 1
    v_add_f32_dpp v44, v44, v44 row_ror:2 row_mask:0xf bank_mask:0xf
    v_add_f32_dpp v45, v45, v45 row_ror:2 row_mask:0xf bank_mask:0xf
    s_nop 1
    v_add_f32_dpp v44, v44, v44 row_ror:1 row_mask:0xf bank_mask:0xf
    v_add_f32_dpp v45, v45, v45 row_ror:1 row_mask:0xf bank_mask:0xf
    v_mov_b32 v46, v44
    v_mov_b32 v47, v45
    s_nop 1
    v_permlane16_swap_b32 v44, v46
    v_permlane16_swap_b32 v45, v47
    s_nop 0
    v_add_f32 v44, v44, v46
    v_add_f32 v45, v45, v47
    v_mov_b32 v46, v44
    v_mov_b32 v47, v45
    s_nop 1
    v_permlane32_swap_b32 v44, v46
    v_permlane32_swap_b32 v45, v47
    s_nop 0
    v_add_f32 v44, v44, v46
    v_add_f32 v45, v45, v47
    ds_write_b64 v3, v[44:45] offset:8192
    s_waitcnt lgkmcnt(0)
    s_barrier
    ds_read_b128 v[20:23], v2 offset:8192
    ds_read_b128 v[24:27], v2 offset:8208
    ds_read_b128 v[28:31], v2 offset:8224
    ds_read_b128 v[32:35], v2 offset:8240
    s_waitcnt lgkmcnt(0)
    v_add_f32 v20, v20, v22
    v_add_f32 v21, v21, v23
    v_add_f32 v24, v24, v26
    v_add_f32 v25, v25, v27
    v_add_f32 v28, v28, v30
    v_add_f32 v29, v29, v31
    v_add_f32 v32, v32, v34
    v_add_f32 v33, v33, v35
    v_add_f32 v20, v20, v24
    v_add_f32 v21, v21, v25
    v_add_f32 v28, v28, v32
    v_add_f32 v29, v29, v33
    v_add_f32 v44, v20, v28
    v_add_f32 v45, v21, v29
    v_mul_f32 v44, 0x3b000000, v44
    v_mul_f32 v45, 0x3b000000, v45
    v_fma_f32 v45, -v44, v44, v45
    v_max_f32 v45, 0, v45
    v_cvt_pk_bf16_f32 v46, v44, v45
    v_lshlrev_b32 v44, 16, v46
    v_and_b32 v45, 0xffff0000, v46
    v_add_f32 v45, 0x3727c5ac, v45
    v_cvt_pk_bf16_f32 v45, v45, v45
    v_lshlrev_b32 v45, 16, v45
    v_sqrt_f32 v45, v45
    s_nop 0
    v_cvt_pk_bf16_f32 v45, v45, v45
    v_lshlrev_b32 v45, 16, v45
    v_sub_f32 v16, v16, v44
    v_cvt_pk_bf16_f32 v16, v16, v16
    v_lshlrev_b32 v16, 16, v16
    v_rcp_f32 v22, v45
    s_nop 0
    v_mul_f32 v23, v16, v22
    v_fma_f32 v20, -v23, v45, v16
    v_fma_f32 v20, v20, v22, v23
    v_cvt_pk_bf16_f32 v16, v20, v20
    v_lshlrev_b32 v16, 16, v16
    v_mul_f32 v16, v16, v126
    v_cvt_pk_bf16_f32 v16, v16, v16
    v_lshlrev_b32 v16, 16, v16
    v_add_f32 v16, v16, v125
    v_cvt_pk_bf16_f32 v16, v16, v16
    v_lshlrev_b32 v16, 16, v16
    v_lshrrev_b32 v5, 2, v0
    v_lshlrev_b32 v5, 2, v5
    v_mov_b32 v44, v16
    v_mul_f32 v45, v16, v16
    s_nop 1
    v_add_f32_dpp v44, v44, v44 row_ror:8 row_mask:0xf bank_mask:0xf
    v_add_f32_dpp v45, v45, v45 row_ror:8 row_mask:0xf bank_mask:0xf
    s_nop 1
    v_add_f32_dpp v44, v44, v44 row_ror:4 row_mask:0xf bank_mask:0xf
    v_add_f32_dpp v45, v45, v45 row_ror:4 row_mask:0xf bank_mask:0xf
    s_nop 1
    v_add_f32_dpp v44, v44, v44 row_ror:2 row_mask:0xf bank_mask:0xf
    v_add_f32_dpp v45, v45, v45 row_ror:2 row_mask:0xf bank_mask:0xf
    s_nop 1
    v_add_f32_dpp v44, v44, v44 row_ror:1 row_mask:0xf bank_mask:0xf
    v_add_f32_dpp v45, v45, v45 row_ror:1 row_mask:0xf bank_mask:0xf
    v_mov_b32 v46, v44
    v_mov_b32 v47, v45
    s_nop 1
    v_permlane16_swap_b32 v44, v46
    v_permlane16_swap_b32 v45, v47
    s_nop 0
    v_add_f32 v44, v44, v46
    v_add_f32 v45, v45, v47
    v_mov_b32 v46, v44
    v_mov_b32 v47, v45
    s_nop 1
    v_permlane32_swap_b32 v44, v46
    v_permlane32_swap_b32 v45, v47
    s_nop 0
    v_add_f32 v44, v44, v46
    v_add_f32 v45, v45, v47
    ds_write_b64 v3, v[44:45] offset:8320
    ds_write_b32 v1, v16
    s_waitcnt lgkmcnt(0)
    s_barrier
    ds_read_b128 v[20:23], v2 offset:8320
    ds_read_b128 v[24:27], v2 offset:8336
    ds_read_b128 v[28:31], v2 offset:8352
    ds_read_b128 v[32:35], v2 offset:8368
    ds_read_b32 v36, v5 offset:0
    ds_read_b32 v37, v5 offset:512
    ds_read_b32 v38, v5 offset:1024
    ds_read_b32 v39, v5 offset:1536
    s_waitcnt lgkmcnt(0)
    v_add_f32 v20, v20, v22
    v_add_f32 v21, v21, v23
    v_add_f32 v24, v24, v26
    v_add_f32 v25, v25, v27
    v_add_f32 v28, v28, v30
    v_add_f32 v29, v29, v31
    v_add_f32 v32, v32, v34
    v_add_f32 v33, v33, v35
    v_add_f32 v20, v20, v24
    v_add_f32 v21, v21, v25
    v_add_f32 v28, v28, v32
    v_add_f32 v29, v29, v33
    v_add_f32 v44, v20, v28
    v_add_f32 v45, v21, v29
    v_mul_f32 v44, 0x3b000000, v44
    v_mul_f32 v45, 0x3b000000, v45
    v_fma_f32 v45, -v44, v44, v45
    v_max_f32 v45, 0, v45
    v_cvt_pk_bf16_f32 v46, v44, v45
    v_lshlrev_b32 v44, 16, v46
    v_and_b32 v45, 0xffff0000, v46
    v_add_f32 v45, 0x3727c5ac, v45
    v_cvt_pk_bf16_f32 v45, v45, v45
    v_lshlrev_b32 v45, 16, v45
    v_sqrt_f32 v45, v45
    s_nop 0
    v_cvt_pk_bf16_f32 v45, v45, v45
    v_lshlrev_b32 v45, 16, v45
    v_sub_f32 v36, v36, v44
    v_sub_f32 v37, v37, v44
    v_sub_f32 v38, v38, v44
    v_sub_f32 v39, v39, v44
    v_cvt_pk_bf16_f32 v20, v36, v37
    v_lshlrev_b32 v36, 16, v20
    v_and_b32 v37, 0xffff0000, v20
    v_cvt_pk_bf16_f32 v20, v38, v39
    v_lshlrev_b32 v38, 16, v20
    v_and_b32 v39, 0xffff0000, v20
    v_rcp_f32 v20, v45
    s_nop 0
    v_mul_f32 v24, v36, v20
    v_mul_f32 v25, v37, v20
    v_mul_f32 v26, v38, v20
    v_mul_f32 v27, v39, v20
    v_fma_f32 v28, -v24, v45, v36
    v_fma_f32 v29, -v25, v45, v37
    v_fma_f32 v30, -v26, v45, v38
    v_fma_f32 v31, -v27, v45, v39
    v_fma_f32 v28, v28, v20, v24
    v_fma_f32 v29, v29, v20, v25
    v_fma_f32 v30, v30, v20, v26
    v_fma_f32 v31, v31, v20, v27
    v_cvt_pk_bf16_f32 v24, v28, v29
    v_lshlrev_b32 v20, 16, v24
    v_and_b32 v21, 0xffff0000, v24
    v_cvt_pk_bf16_f32 v24, v30, v31
    v_lshlrev_b32 v22, 16, v24
    v_and_b32 v23, 0xffff0000, v24
    v_lshlrev_b32 v42, 16, v128
    v_and_b32 v43, 0xffff0000, v128
    v_mul_f32 v48, v20, v42
    v_mul_f32 v49, v20, v43
    v_lshlrev_b32 v42, 16, v129
    v_and_b32 v43, 0xffff0000, v129
    v_mul_f32 v50, v20, v42
    v_mul_f32 v51, v20, v43
    v_lshlrev_b32 v42, 16, v130
    v_and_b32 v43, 0xffff0000, v130
    v_mul_f32 v52, v20, v42
    v_mul_f32 v53, v20, v43
    v_lshlrev_b32 v42, 16, v131
    v_and_b32 v43, 0xffff0000, v131
    v_mul_f32 v54, v20, v42
    v_mul_f32 v55, v20, v43
    v_lshlrev_b32 v42, 16, v132
    v_and_b32 v43, 0xffff0000, v132
    v_fmac_f32 v48, v21, v42
    v_fmac_f32 v49, v21, v43
    v_lshlrev_b32 v42, 16, v133
    v_and_b32 v43, 0xffff0000, v133
    v_fmac_f32 v50, v21, v42
    v_fmac_f32 v51, v21, v43
    v_lshlrev_b32 v42, 16, v134
    v_and_b32 v43, 0xffff0000, v134
    v_fmac_f32 v52, v21, v42
    v_fmac_f32 v53, v21, v43
    v_lshlrev_b32 v42, 16, v135
    v_and_b32 v43, 0xffff0000, v135
    v_fmac_f32 v54, v21, v42
    v_fmac_f32 v55, v21, v43
    v_lshlrev_b32 v42, 16, v136
    v_and_b32 v43, 0xffff0000, v136
    v_fmac_f32 v48, v22, v42
    v_fmac_f32 v49, v22, v43
    v_lshlrev_b32 v42, 16, v137
    v_and_b32 v43, 0xffff0000, v137
    v_fmac_f32 v50, v22, v42
    v_fmac_f32 v51, v22, v43
    v_lshlrev_b32 v42, 16, v138
    v_and_b32 v43, 0xffff0000, v138
    v_fmac_f32 v52, v22, v42
    v_fmac_f32 v53, v22, v43
    v_lshlrev_b32 v42, 16, v139
    v_and_b32 v43, 0xffff0000, v139
    v_fmac_f32 v54, v22, v42
    v_fmac_f32 v55, v22, v43
    v_lshlrev_b32 v42, 16, v140
    v_and_b32 v43, 0xffff0000, v140
    v_fmac_f32 v48, v23, v42
    v_fmac_f32 v49, v23, v43
    v_lshlrev_b32 v42, 16, v141
    v_and_b32 v43, 0xffff0000, v141
    v_fmac_f32 v50, v23, v42
    v_fmac_f32 v51, v23, v43
    v_lshlrev_b32 v42, 16, v142
    v_and_b32 v43, 0xffff0000, v142
    v_fmac_f32 v52, v23, v42
    v_fmac_f32 v53, v23, v43
    v_lshlrev_b32 v42, 16, v143
    v_and_b32 v43, 0xffff0000, v143
    v_fmac_f32 v54, v23, v42
    v_fmac_f32 v55, v23, v43
    s_nop 1
    v_permlane32_swap_b32 v48, v52
    v_permlane32_swap_b32 v49, v53
    v_permlane32_swap_b32 v50, v54
    v_permlane32_swap_b32 v51, v55
    s_nop 0
    v_add_f32 v48, v48, v52
    v_add_f32 v49, v49, v53
    v_add_f32 v50, v50, v54
    v_add_f32 v51, v51, v55
    s_nop 0
    v_permlane16_swap_b32 v48, v50
    v_permlane16_swap_b32 v49, v51
    s_nop 0
    v_add_f32 v48, v48, v50
    v_add_f32 v49, v49, v51
    s_nop 1
    v_add_f32_dpp v48, v48, v48 row_ror:8 row_mask:0xf bank_mask:0xf
    v_add_f32_dpp v49, v49, v49 row_ror:8 row_mask:0xf bank_mask:0xf
    s_nop 1
    v_add_f32_dpp v48, v48, v48 row_ror:4 row_mask:0xf bank_mask:0xf
    v_add_f32_dpp v49, v49, v49 row_ror:4 row_mask:0xf bank_mask:0xf
    s_lshl_b32 s3, s39, 7
    v_and_b32 v5, 3, v0
    v_lshlrev_b32 v3, 5, v5
    v_add_u32 v3, s3, v3
    v_bfe_u32 v5, v0, 4, 1
    v_lshl_add_u32 v3, v5, 3, v3
    v_bfe_u32 v5, v0, 5, 1
    v_lshl_add_u32 v3, v5, 4, v3
    ds_write_b64 v3, v[48:49] offset:9216
    s_lshr_b32 s28, s39, 2
    s_lshl_b32 s28, s28, 4
    v_add_u32 v3, s28, v0
    v_and_b32 v3, 31, v3
    v_lshlrev_b32 v3, 2, v3
    ds_bpermute_b32 v45, v3, v121
    s_waitcnt lgkmcnt(0)
    s_barrier
    ds_read_b32 v8, v3 offset:9216
    ds_read_b32 v9, v3 offset:9344
    ds_read_b32 v10, v3 offset:9472
    ds_read_b32 v11, v3 offset:9600
    ds_read_b32 v12, v3 offset:9728
    ds_read_b32 v13, v3 offset:9856
    ds_read_b32 v14, v3 offset:9984
    ds_read_b32 v15, v3 offset:10112
    s_waitcnt lgkmcnt(0)
    v_add_f32 v8, v8, v9
    v_add_f32 v10, v10, v11
    v_add_f32 v12, v12, v13
    v_add_f32 v14, v14, v15
    v_add_f32 v8, v8, v10
    v_add_f32 v12, v12, v14
    v_add_f32 v8, v8, v12
    v_cvt_pk_bf16_f32 v8, v8, v8
    v_lshlrev_b32 v8, 16, v8
    v_lshlrev_b32 v45, 16, v45
    v_add_f32 v8, v8, v45
    v_cvt_pk_bf16_f32 v8, v8, v8
    v_lshlrev_b32 v8, 16, v8
    v_mul_f32 v9, v8, v8
    v_mov_b32 v10, 0x3d372713
    v_fma_f32 v9, v9, v10, 1.0
    v_mul_f32 v9, v9, v8
    v_mul_f32 v9, 0xc0135761, v9
    v_exp_f32 v9, v9
    s_nop 0
    v_add_f32 v9, 1.0, v9
    v_rcp_f32 v9, v9
    s_nop 0
    v_mul_f32 v8, v8, v9
    v_cvt_pk_bf16_f32 v8, v8, v8
    v_lshlrev_b32 v8, 16, v8
    s_nop 0
    v_readlane_b32 s80, v8, 0
    v_readlane_b32 s81, v8, 1
    v_readlane_b32 s82, v8, 2
    v_readlane_b32 s83, v8, 3
    v_readlane_b32 s84, v8, 4
    v_readlane_b32 s85, v8, 5
    v_readlane_b32 s86, v8, 6
    v_readlane_b32 s87, v8, 7
    v_readlane_b32 s88, v8, 8
    v_readlane_b32 s89, v8, 9
    v_readlane_b32 s90, v8, 10
    v_readlane_b32 s91, v8, 11
    v_readlane_b32 s92, v8, 12
    v_readlane_b32 s93, v8, 13
    v_readlane_b32 s94, v8, 14
    v_readlane_b32 s95, v8, 15
    s_waitcnt vmcnt(0)
    v_lshlrev_b32 v44, 16, v144
    v_and_b32 v45, 0xffff0000, v144
    v_mul_f32 v42, s80, v44
    v_mul_f32 v43, s80, v45
    v_lshlrev_b32 v44, 16, v145
    v_and_b32 v45, 0xffff0000, v145
    v_fmac_f32 v42, s81, v44
    v_fmac_f32 v43, s81, v45
    v_lshlrev_b32 v44, 16, v146
    v_and_b32 v45, 0xffff0000, v146
    v_fmac_f32 v42, s82, v44
    v_fmac_f32 v43, s82, v45
    v_lshlrev_b32 v44, 16, v147
    v_and_b32 v45, 0xffff0000, v147
    v_fmac_f32 v42, s83, v44
    v_fmac_f32 v43, s83, v45
    v_lshlrev_b32 v44, 16, v148
    v_and_b32 v45, 0xffff0000, v148
    v_fmac_f32 v42, s84, v44
    v_fmac_f32 v43, s84, v45
    v_lshlrev_b32 v44, 16, v149
    v_and_b32 v45, 0xffff0000, v149
    v_fmac_f32 v42, s85, v44
    v_fmac_f32 v43, s85, v45
    v_lshlrev_b32 v44, 16, v150
    v_and_b32 v45, 0xffff0000, v150
    v_fmac_f32 v42, s86, v44
    v_fmac_f32 v43, s86, v45
    v_lshlrev_b32 v44, 16, v151
    v_and_b32 v45, 0xffff0000, v151
    v_fmac_f32 v42, s87, v44
    v_fmac_f32 v43, s87, v45
    v_lshlrev_b32 v44, 16, v152
    v_and_b32 v45, 0xffff0000, v152
    v_fmac_f32 v42, s88, v44
    v_fmac_f32 v43, s88, v45
    v_lshlrev_b32 v44, 16, v153
    v_and_b32 v45, 0xffff0000, v153
    v_fmac_f32 v42, s89, v44
    v_fmac_f32 v43, s89, v45
    v_lshlrev_b32 v44, 16, v154
    v_and_b32 v45, 0xffff0000, v154
    v_fmac_f32 v42, s90, v44
    v_fmac_f32 v43, s90, v45
    v_lshlrev_b32 v44, 16, v155
    v_and_b32 v45, 0xffff0000, v155
    v_fmac_f32 v42, s91, v44
    v_fmac_f32 v43, s91, v45
    v_lshlrev_b32 v44, 16, v156
    v_and_b32 v45, 0xffff0000, v156
    v_fmac_f32 v42, s92, v44
    v_fmac_f32 v43, s92, v45
    v_lshlrev_b32 v44, 16, v157
    v_and_b32 v45, 0xffff0000, v157
    v_fmac_f32 v42, s93, v44
    v_fmac_f32 v43, s93, v45
    v_lshlrev_b32 v44, 16, v158
    v_and_b32 v45, 0xffff0000, v158
    v_fmac_f32 v42, s94, v44
    v_fmac_f32 v43, s94, v45
    v_lshlrev_b32 v44, 16, v159
    v_and_b32 v45, 0xffff0000, v159
    v_fmac_f32 v42, s95, v44
    v_fmac_f32 v43, s95, v45
    v_and_b32 v1, 255, v0
    v_lshlrev_b32 v1, 3, v1
    s_cmp_lt_u32 s39, 4
    s_cbranch_scc1 G_LO
    ds_write_b64 v1, v[42:43] offset:10240
    s_waitcnt lgkmcnt(0)
    s_barrier
    s_branch K_TS
G_LO:
    s_barrier
    ds_read_b64 v[44:45], v1 offset:10240
    s_lshl_b32 s3, s76, 11
    s_add_u32 s3, s3, 458752
    s_waitcnt lgkmcnt(0)
    v_add_f32 v42, v42, v44
    v_add_f32 v43, v43, v45
    buffer_store_dwordx2 v[42:43], v1, s[4:7], s3 offen sc1
    s_branch K_TS
H_GO:
    s_sub_u32 s28, s2, 205
    v_lshrrev_b32 v4, 4, v0
    v_and_b32 v5, 15, v0
    v_lshlrev_b32 v1, 11, v4
    v_lshl_add_u32 v1, v5, 4, v1
    s_lshl_b32 s3, s28, 8
    s_add_u32 s24, s3, 393216
    s_add_u32 s25, s3, 458752
    s_add_u32 s26, s25, 65536
    v_mov_b32 v16, 0
    v_mov_b32 v17, 0
    v_mov_b32 v18, 0
    v_mov_b32 v19, 0
    v_mov_b32 v24, 0
    v_mov_b32 v25, 0
    v_mov_b32 v26, 0
    v_mov_b32 v27, 0
    s_cmp_ge_u32 s39, 2
    s_cbranch_scc1 H_SK0
    s_mov_b32 s38, 0
GA13:
    buffer_load_dwordx4 v[16:19], v1, s[4:7], s24 offen sc1
    s_add_u32 s38, s38, 1
    s_waitcnt vmcnt(0)
    v_max3_u32 v70, v16, v17, v18
    v_max_u32 v70, v70, v19
    v_cmp_eq_u32 vcc, -1, v70
    s_cmp_gt_u32 s38, 0x40000
    s_cbranch_scc1 GD14
    s_nop 2
    s_cmp_eq_u64 vcc, 0
    s_cbranch_scc1 GD14
    s_sleep 1
    s_branch GA13
GD14:
H_SK0:
    v_mov_b32 v44, v16
    v_mov_b32 v45, v17
    v_mov_b32 v46, v18
    v_mov_b32 v47, v19
    s_nop 0
    v_permlane16_swap_b32 v16, v44
    v_permlane16_swap_b32 v17, v45
    v_permlane16_swap_b32 v18, v46
    v_permlane16_swap_b32 v19, v47
    s_nop 0
    v_add_f32 v16, v16, v44
    v_add_f32 v17, v17, v45
    v_add_f32 v18, v18, v46
    v_add_f32 v19, v19, v47
    v_mov_b32 v44, v16
    v_mov_b32 v45, v17
    v_mov_b32 v46, v18
    v_mov_b32 v47, v19
    s_nop 0
    v_permlane32_swap_b32 v16, v44
    v_permlane32_swap_b32 v17, v45
    v_permlane32_swap_b32 v18, v46
    v_permlane32_swap_b32 v19, v47
    s_nop 0
    v_add_f32 v16, v16, v44
    v_add_f32 v17, v17, v45
    v_add_f32 v18, v18, v46
    v_add_f32 v19, v19, v47
    s_lshl_b32 s3, s39, 8
    v_lshl_add_u32 v2, v5, 4, s3
    ds_write_b128 v2, v[16:19] offset:0
    v_lshlrev_b32 v6, 4, v0
    s_waitcnt lgkmcnt(0)
    v_mov_b32 v16, v124
    v_mov_b32 v17, v127
    v_lshlrev_b32 v18, 16, v120
    v_lshlrev_b32 v19, 16, v122
    ds_write_b128 v6, v[16:19] offset:4096
    v_cmp_gt_u32 vcc, 11, v4
    s_and_saveexec_b64 s[34:35], vcc
    s_cbranch_execz H_SK
    s_mov_b32 s38, 0
GA16:
    buffer_load_dwordx4 v[24:27], v1, s[4:7], s26 offen sc1
    s_add_u32 s38, s38, 1
    s_waitcnt vmcnt(0)
    v_max3_u32 v70, v24, v25, v26
    v_max_u32 v70, v70, v27
    v_cmp_eq_u32 vcc, -1, v70
    s_cmp_gt_u32 s38, 0x40000
    s_cbranch_scc1 GD17
    s_nop 2
    s_cmp_eq_u64 vcc, 0
    s_cbranch_scc1 GD17
    s_sleep 1
    s_branch GA16
GD17:
H_SK:
    s_mov_b64 exec, s[34:35]
    s_mov_b32 s38, 0
GA19:
    buffer_load_dwordx4 v[20:23], v1, s[4:7], s25 offen sc1
    s_add_u32 s38, s38, 1
    s_waitcnt vmcnt(0)
    v_max3_u32 v70, v20, v21, v22
    v_max_u32 v70, v70, v23
    v_cmp_eq_u32 vcc, -1, v70
    s_cmp_gt_u32 s38, 0x40000
    s_cbranch_scc1 GD20
    s_nop 2
    s_cmp_eq_u64 vcc, 0
    s_cbranch_scc1 GD20
    s_sleep 1
    s_branch GA19
GD20:
    v_add_f32 v20, v20, v24
    v_add_f32 v21, v21, v25
    v_add_f32 v22, v22, v26
    v_add_f32 v23, v23, v27
    v_mov_b32 v44, v20
    v_mov_b32 v45, v21
    v_mov_b32 v46, v22
    v_mov_b32 v47, v23
    s_nop 0
    v_permlane16_swap_b32 v20, v44
    v_permlane16_swap_b32 v21, v45
    v_permlane16_swap_b32 v22, v46
    v_permlane16_swap_b32 v23, v47
    s_nop 0
    v_add_f32 v20, v20, v44
    v_add_f32 v21, v21, v45
    v_add_f32 v22, v22, v46
    v_add_f32 v23, v23, v47
    v_mov_b32 v44, v20
    v_mov_b32 v45, v21
    v_mov_b32 v46, v22
    v_mov_b32 v47, v23
    s_nop 0
    v_permlane32_swap_b32 v20, v44
    v_permlane32_swap_b32 v21, v45
    v_permlane32_swap_b32 v22, v46
    v_permlane32_swap_b32 v23, v47
    s_nop 0
    v_add_f32 v20, v20, v44
    v_add_f32 v21, v21, v45
    v_add_f32 v22, v22, v46
    v_add_f32 v23, v23, v47
    s_lshl_b32 s3, s39, 8
    v_lshl_add_u32 v2, v5, 4, s3
    ds_write_b128 v2, v[20:23] offset:2048
    s_waitcnt lgkmcnt(0)
    s_barrier
    s_cmp_lg_u32 s39, 0
    s_cbranch_scc1 K_TS
    s_lshl_b32 s3, s28, 10
    v_add_u32 v2, s3, v6
    ds_read_b128 v[24:27], v2 offset:4096
    v_lshlrev_b32 v1, 2, v0
    ds_read_b32 v8, v1 offset:0
    ds_read_b32 v9, v1 offset:256
    ds_read_b32 v10, v1 offset:512
    ds_read_b32 v11, v1 offset:768
    ds_read_b32 v12, v1 offset:1024
    ds_read_b32 v13, v1 offset:1280
    ds_read_b32 v14, v1 offset:1536
    ds_read_b32 v15, v1 offset:1792
    s_waitcnt lgkmcnt(0)
    v_add_f32 v8, v8, v9
    v_add_f32 v10, v10, v11
    v_add_f32 v12, v12, v13
    v_add_f32 v14, v14, v15
    v_add_f32 v8, v8, v10
    v_add_f32 v12, v12, v14
    v_add_f32 v8, v8, v12
    v_mov_b32 v16, v8
    ds_read_b32 v8, v1 offset:2048
    ds_read_b32 v9, v1 offset:2304
    ds_read_b32 v10, v1 offset:2560
    ds_read_b32 v11, v1 offset:2816
    ds_read_b32 v12, v1 offset:3072
    ds_read_b32 v13, v1 offset:3328
    ds_read_b32 v14, v1 offset:3584
    ds_read_b32 v15, v1 offset:3840
    s_waitcnt lgkmcnt(0)
    v_add_f32 v8, v8, v9
    v_add_f32 v10, v10, v11
    v_add_f32 v12, v12, v13
    v_add_f32 v14, v14, v15
    v_add_f32 v8, v8, v10
    v_add_f32 v12, v12, v14
    v_add_f32 v8, v8, v12
    v_mov_b32 v17, v8
    v_cvt_pk_bf16_f32 v20, v16, v17
    v_lshlrev_b32 v16, 16, v20
    v_and_b32 v17, 0xffff0000, v20
    v_mul_f32 v16, v16, v24
    v_add_f32 v17, v17, v27
    v_cvt_pk_bf16_f32 v20, v16, v17
    v_lshlrev_b32 v16, 16, v20
    v_and_b32 v17, 0xffff0000, v20
    v_add_f32 v16, v16, v26
    v_mul_f32 v17, v17, v25
    v_cvt_pk_bf16_f32 v20, v16, v17
    v_lshlrev_b32 v16, 16, v20
    v_and_b32 v17, 0xffff0000, v20
    s_mov_b32 s16, s66
    s_mov_b32 s17, s67
    s_mov_b32 s18, 1024
    s_mov_b32 s19, 0x20000
    v_add_f32 v16, v16, v17
    v_cvt_pk_bf16_f32 v16, v16, v16
    v_lshlrev_b32 v1, 1, v0
    s_lshl_b32 s3, s28, 7
    buffer_store_short v16, v1, s[16:19], s3 offen
K_TS:
    s_endpgm
AUX:
    v_subrev_u32 v0, 512, v0
    v_and_b32 v11, 63, v0
    v_lshlrev_b32 v11, 4, v11
    s_lshl_b32 s3, s32, 8
    v_lshl_add_u32 v6, v0, 1, s3
    s_waitcnt lgkmcnt(0)
    s_mov_b32 s4, s70
    s_mov_b32 s5, s71
    s_mov_b32 s6, 6291456
    s_mov_b32 s7, 0x20000
    s_mov_b32 s8, s68
    s_mov_b32 s9, s69
    s_mov_b32 s10, 256
    s_mov_b32 s11, 0x20000
    s_mov_b32 s12, s40
    s_mov_b32 s13, s41
    s_mov_b32 s14, 1024
    s_mov_b32 s15, 0x20000
    buffer_load_dwordx4 v[56:59], v11, s[12:15], 0 offen
    buffer_load_ushort v46, v6, s[12:15], 0 offen
    s_cmp_lt_u32 s2, 192
    s_cbranch_scc1 X_NOINIT
    s_cmp_ge_u32 s2, 208
    s_cbranch_scc1 X_NOINIT
    s_barrier
    s_cmp_ge_u32 s2, 198
    s_cbranch_scc1 X_NOINIT
    s_barrier
X_NOINIT:
    s_waitcnt vmcnt(0)
    v_and_b32 v61, 0xffff0000, v56
    v_lshlrev_b32 v60, 16, v56
    v_and_b32 v63, 0xffff0000, v57
    v_lshlrev_b32 v62, 16, v57
    v_and_b32 v65, 0xffff0000, v58
    v_lshlrev_b32 v64, 16, v58
    v_and_b32 v67, 0xffff0000, v59
    v_lshlrev_b32 v66, 16, v59
    v_add_f32 v44, v60, v61
    v_add_f32 v44, v44, v62
    v_add_f32 v44, v44, v63
    v_add_f32 v44, v44, v64
    v_add_f32 v44, v44, v65
    v_add_f32 v44, v44, v66
    v_add_f32 v44, v44, v67
    s_nop 1
    v_add_f32_dpp v44, v44, v44 row_ror:8 row_mask:0xf bank_mask:0xf
    s_nop 1
    v_add_f32_dpp v44, v44, v44 row_ror:4 row_mask:0xf bank_mask:0xf
    s_nop 1
    v_add_f32_dpp v44, v44, v44 row_ror:2 row_mask:0xf bank_mask:0xf
    s_nop 1
    v_add_f32_dpp v44, v44, v44 row_ror:1 row_mask:0xf bank_mask:0xf
    v_mov_b32 v47, v44
    s_nop 1
    v_permlane16_swap_b32 v44, v47
    s_nop 0
    v_add_f32 v44, v44, v47
    v_mov_b32 v47, v44
    s_nop 1
    v_permlane32_swap_b32 v44, v47
    s_nop 0
    v_add_f32 v44, v44, v47
    v_mul_f32 v44, 0x3b000000, v44
    v_mov_b32 v45, 0
    v_sub_f32 v47, v60, v44
    v_fmac_f32 v45, v47, v47
    v_sub_f32 v47, v61, v44
    v_fmac_f32 v45, v47, v47
    v_sub_f32 v47, v62, v44
    v_fmac_f32 v45, v47, v47
    v_sub_f32 v47, v63, v44
    v_fmac_f32 v45, v47, v47
    v_sub_f32 v47, v64, v44
    v_fmac_f32 v45, v47, v47
    v_sub_f32 v47, v65, v44
    v_fmac_f32 v45, v47, v47
    v_sub_f32 v47, v66, v44
    v_fmac_f32 v45, v47, v47
    v_sub_f32 v47, v67, v44
    v_fmac_f32 v45, v47, v47
    s_nop 1
    v_add_f32_dpp v45, v45, v45 row_ror:8 row_mask:0xf bank_mask:0xf
    s_nop 1
    v_add_f32_dpp v45, v45, v45 row_ror:4 row_mask:0xf bank_mask:0xf
    s_nop 1
    v_add_f32_dpp v45, v45, v45 row_ror:2 row_mask:0xf bank_mask:0xf
    s_nop 1
    v_add_f32_dpp v45, v45, v45 row_ror:1 row_mask:0xf bank_mask:0xf
    v_mov_b32 v47, v45
    s_nop 1
    v_permlane16_swap_b32 v45, v47
    s_nop 0
    v_add_f32 v45, v45, v47
    v_mov_b32 v47, v45
    s_nop 1
    v_permlane32_swap_b32 v45, v47
    s_nop 0
    v_add_f32 v45, v45, v47
    v_mul_f32 v45, 0x3b000000, v45
    v_cvt_pk_bf16_f32 v47, v44, v45
    v_lshlrev_b32 v44, 16, v47
    v_and_b32 v45, 0xffff0000, v47
    v_add_f32 v45, 0x3727c5ac, v45
    v_cvt_pk_bf16_f32 v45, v45, v45
    v_lshlrev_b32 v45, 16, v45
    v_sqrt_f32 v45, v45
    s_nop 0
    v_cvt_pk_bf16_f32 v45, v45, v45
    v_lshlrev_b32 v45, 16, v45
    v_lshlrev_b32 v46, 16, v46
    v_sub_f32 v46, v46, v44
    v_cvt_pk_bf16_f32 v46, v46, v46
    v_lshlrev_b32 v46, 16, v46
    v_rcp_f32 v20, v45
    s_nop 0
    v_mul_f32 v21, v46, v20
    v_fma_f32 v18, -v21, v45, v46
    v_fma_f32 v18, v18, v20, v21
    v_cvt_pk_bf16_f32 v46, v18, v18
    v_lshlrev_b32 v46, 16, v46
    v_lshlrev_b32 v1, 2, v0
    s_cmp_lg_u32 s39, 8
    s_cbranch_scc1 X_B1
    s_mov_b32 s38, 0
    v_min_u32 v71, 5, v0
    v_lshlrev_b32 v71, 2, v71
WA22:
    buffer_load_dword v70, v71, s[8:11], 0 offen offset:128 sc1
    s_add_u32 s38, s38, 1
    s_waitcnt vmcnt(0)
    v_cmp_eq_u32 vcc, 0, v70
    s_cmp_gt_u32 s38, 0x40000
    s_cbranch_scc1 WD23
    s_nop 2
    s_cmp_eq_u64 vcc, 0
    s_cbranch_scc1 WD23
    s_sleep 2
    s_branch WA22
WD23:
X_B1:
    s_barrier
    s_cmp_ge_u32 s2, 192
    s_cbranch_scc1 X_A
    s_cmp_lg_u32 s39, 8
    s_cbranch_scc1 X_A
    ds_read_b32 v8, v1 offset:0
    ds_read_b32 v9, v1 offset:256
    ds_read_b32 v10, v1 offset:512
    ds_read_b32 v11, v1 offset:768
    ds_read_b32 v12, v1 offset:1024
    ds_read_b32 v13, v1 offset:1280
    ds_read_b32 v14, v1 offset:1536
    ds_read_b32 v15, v1 offset:1792
    s_waitcnt lgkmcnt(0)
    v_add_f32 v8, v8, v9
    v_add_f32 v10, v10, v11
    v_add_f32 v12, v12, v13
    v_add_f32 v14, v14, v15
    v_add_f32 v8, v8, v10
    v_add_f32 v12, v12, v14
    v_add_f32 v8, v8, v12
    s_mul_i32 s3, s32, 12288
    s_lshl_b32 s28, s33, 8
    s_add_u32 s3, s3, s28
    buffer_store_dword v8, v1, s[4:7], s3 offen offset:0 sc1
X_A:
    s_barrier
    v_lshlrev_b32 v6, 1, v6
    s_mov_b32 s25, 12288
    s_mov_b32 s26, 24576
    s_mov_b32 s27, 36864
    s_mov_b32 s38, 0
GA24:
    buffer_load_dword v16, v6, s[4:7], 0 offen offset:0 sc1
    buffer_load_dword v17, v6, s[4:7], 0 offen offset:2048 sc1
    buffer_load_dword v18, v6, s[4:7], s25 offen offset:0 sc1
    buffer_load_dword v19, v6, s[4:7], s25 offen offset:2048 sc1
    buffer_load_dword v20, v6, s[4:7], s26 offen offset:0 sc1
    buffer_load_dword v21, v6, s[4:7], s26 offen offset:2048 sc1
    buffer_load_dword v22, v6, s[4:7], s27 offen offset:0 sc1
    buffer_load_dword v23, v6, s[4:7], s27 offen offset:2048 sc1
    s_add_u32 s38, s38, 1
    s_waitcnt vmcnt(0)
    v_max3_u32 v70, v16, v17, v18
    v_max3_u32 v70, v70, v19, v20
    v_max3_u32 v70, v70, v21, v22
    v_max_u32 v70, v70, v23
    v_cmp_eq_u32 vcc, -1, v70
    s_cmp_gt_u32 s38, 0x40000
    s_cbranch_scc1 GD25
    s_nop 2
    s_cmp_eq_u64 vcc, 0
    s_cbranch_scc1 GD25
    s_sleep 1
    s_branch GA24
GD25:
    v_add_f32 v16, v16, v18
    v_add_f32 v20, v20, v22
    v_add_f32 v17, v17, v19
    v_add_f32 v21, v21, v23
    v_add_f32 v16, v16, v20
    v_add_f32 v17, v17, v21
    v_cvt_pk_bf16_f32 v47, v16, v17
    v_lshlrev_b32 v16, 16, v47
    v_and_b32 v17, 0xffff0000, v47
    v_add_f32 v17, 1.0, v17
    v_cvt_pk_bf16_f32 v17, v17, v17
    v_lshlrev_b32 v17, 16, v17
    v_mul_f32 v18, v46, v17
    v_cvt_pk_bf16_f32 v18, v18, v18
    v_lshlrev_b32 v18, 16, v18
    v_add_f32 v18, v18, v16
    v_cvt_pk_bf16_f32 v18, v18, v18
    v_lshlrev_b32 v18, 16, v18
    ds_write_b32 v1, v18 offset:4096
    s_waitcnt lgkmcnt(0)
    s_barrier
    s_cmp_lg_u32 s39, 8
    s_cbranch_scc1 X_PI
    s_mov_b32 s38, 0
    v_mov_b32 v71, 0
WA27:
    buffer_load_dword v70, v71, s[8:11], 0 offen offset:0 sc1
    s_add_u32 s38, s38, 1
    s_waitcnt vmcnt(0)
    v_readfirstlane_b32 s3, v70
    s_cmp_gt_u32 s38, 0x40000
    s_cbranch_scc1 WD28
    s_cmp_ge_u32 s3, 16
    s_cbranch_scc1 WD28
    s_sleep 2
    s_branch WA27
WD28:
    s_branch X_B3
X_PI:
    v_mov_b32 v16, -1
    v_mov_b32 v17, -1
    v_mov_b32 v18, -1
    v_mov_b32 v19, -1
    v_and_b32 v11, 63, v0
    v_lshlrev_b32 v11, 4, v11
    s_lshr_b32 s3, s2, 6
    s_lshl_b32 s3, s3, 19
    s_and_b32 s28, s2, 63
    s_lshl_b32 s28, s28, 10
    s_add_u32 s3, s3, s28
    s_add_u32 s3, s3, 1048576
    buffer_store_dwordx4 v[16:19], v11, s[4:7], s3 offen sc1
    s_add_u32 s3, s3, 65536
    buffer_store_dwordx4 v[16:19], v11, s[4:7], s3 offen sc1
    s_add_u32 s3, s3, 65536
    buffer_store_dwordx4 v[16:19], v11, s[4:7], s3 offen sc1
    s_add_u32 s3, s3, 65536
    buffer_store_dwordx4 v[16:19], v11, s[4:7], s3 offen sc1
    s_add_u32 s3, s3, 65536
    buffer_store_dwordx4 v[16:19], v11, s[4:7], s3 offen sc1
    s_add_u32 s3, s3, 65536
    buffer_store_dwordx4 v[16:19], v11, s[4:7], s3 offen sc1
    s_add_u32 s3, s3, 65536
    buffer_store_dwordx4 v[16:19], v11, s[4:7], s3 offen sc1
    s_add_u32 s3, s3, 65536
    buffer_store_dwordx4 v[16:19], v11, s[4:7], s3 offen sc1
X_B3:
    s_barrier
    s_cmp_lg_u32 s39, 8
    s_cbranch_scc1 X_Q
    ds_read_b32 v8, v1 offset:2048
    ds_read_b32 v9, v1 offset:2304
    ds_read_b32 v10, v1 offset:2560
    ds_read_b32 v11, v1 offset:2816
    ds_read_b32 v12, v1 offset:3072
    ds_read_b32 v13, v1 offset:3328
    ds_read_b32 v14, v1 offset:3584
    ds_read_b32 v15, v1 offset:3840
    s_waitcnt lgkmcnt(0)
    v_add_f32 v8, v8, v9
    v_add_f32 v10, v10, v11
    v_add_f32 v12, v12, v13
    v_add_f32 v14, v14, v15
    v_add_f32 v8, v8, v10
    v_add_f32 v12, v12, v14
    v_add_f32 v8, v8, v12
    s_lshl_b32 s3, s2, 8
    s_add_u32 s3, s3, 65536
    buffer_store_dword v8, v1, s[4:7], s3 offen sc1
X_Q:
    s_barrier
    v_and_b32 v7, 63, v0
    v_lshlrev_b32 v7, 2, v7
    s_lshl_b32 s3, s30, 11
    s_sub_u32 s28, s39, 8
    s_lshl_b32 s28, s28, 10
    s_add_u32 s3, s3, s28
    s_add_u32 s3, s3, 65536
    s_mov_b32 s38, 0
GA29:
    buffer_load_dword v16, v7, s[4:7], s3 offen offset:0 sc1
    buffer_load_dword v17, v7, s[4:7], s3 offen offset:256 sc1
    buffer_load_dword v18, v7, s[4:7], s3 offen offset:512 sc1
    buffer_load_dword v19, v7, s[4:7], s3 offen offset:768 sc1
    s_add_u32 s38, s38, 1
    s_waitcnt vmcnt(0)
    v_max3_u32 v70, v16, v17, v18
    v_max_u32 v70, v70, v19
    v_cmp_eq_u32 vcc, -1, v70
    s_cmp_gt_u32 s38, 0x40000
    s_cbranch_scc1 GD30
    s_nop 2
    s_cmp_eq_u64 vcc, 0
    s_cbranch_scc1 GD30
    s_sleep 1
    s_branch GA29
GD30:
    v_add_f32 v16, v16, v17
    v_add_f32 v18, v18, v19
    v_add_f32 v16, v16, v18
    v_cvt_pk_bf16_f32 v16, v16, v16
    v_lshlrev_b32 v16, 16, v16
    ds_write_b32 v1, v16 offset:4608
    s_waitcnt lgkmcnt(0)
    s_barrier
    s_barrier
    s_barrier
    s_barrier
    s_cmp_lt_u32 s2, 205
    s_cbranch_scc1 X_MGD
    s_mov_b32 s24, 4096
    s_mov_b32 s25, 16384
    s_mov_b32 s26, 28672
    s_mov_b32 s27, 40960
    v_add_u32 v6, 4096, v1
    s_mov_b32 s38, 0
GA32:
    buffer_load_dword v72, v1, s[4:7], s24 offen offset:0 sc1
    buffer_load_dword v73, v1, s[4:7], s24 offen offset:2048 sc1
    buffer_load_dword v74, v6, s[4:7], s24 offen offset:0 sc1
    buffer_load_dword v75, v6, s[4:7], s24 offen offset:2048 sc1
    buffer_load_dword v76, v1, s[4:7], s25 offen offset:0 sc1
    buffer_load_dword v77, v1, s[4:7], s25 offen offset:2048 sc1
    buffer_load_dword v78, v6, s[4:7], s25 offen offset:0 sc1
    buffer_load_dword v79, v6, s[4:7], s25 offen offset:2048 sc1
    buffer_load_dword v80, v1, s[4:7], s26 offen offset:0 sc1
    buffer_load_dword v81, v1, s[4:7], s26 offen offset:2048 sc1
    buffer_load_dword v82, v6, s[4:7], s26 offen offset:0 sc1
    buffer_load_dword v83, v6, s[4:7], s26 offen offset:2048 sc1
    buffer_load_dword v84, v1, s[4:7], s27 offen offset:0 sc1
    buffer_load_dword v85, v1, s[4:7], s27 offen offset:2048 sc1
    buffer_load_dword v86, v6, s[4:7], s27 offen offset:0 sc1
    buffer_load_dword v87, v6, s[4:7], s27 offen offset:2048 sc1
    buffer_load_dword v88, v1, s[4:7], s24 offen offset:512 sc1
    buffer_load_dword v89, v1, s[4:7], s24 offen offset:2560 sc1
    buffer_load_dword v90, v6, s[4:7], s24 offen offset:512 sc1
    buffer_load_dword v91, v6, s[4:7], s24 offen offset:2560 sc1
    buffer_load_dword v92, v1, s[4:7], s25 offen offset:512 sc1
    buffer_load_dword v93, v1, s[4:7], s25 offen offset:2560 sc1
    buffer_load_dword v94, v6, s[4:7], s25 offen offset:512 sc1
    buffer_load_dword v95, v6, s[4:7], s25 offen offset:2560 sc1
    buffer_load_dword v96, v1, s[4:7], s26 offen offset:512 sc1
    buffer_load_dword v97, v1, s[4:7], s26 offen offset:2560 sc1
    buffer_load_dword v98, v6, s[4:7], s26 offen offset:512 sc1
    buffer_load_dword v99, v6, s[4:7], s26 offen offset:2560 sc1
    buffer_load_dword v100, v1, s[4:7], s27 offen offset:512 sc1
    buffer_load_dword v101, v1, s[4:7], s27 offen offset:2560 sc1
    buffer_load_dword v102, v6, s[4:7], s27 offen offset:512 sc1
    buffer_load_dword v103, v6, s[4:7], s27 offen offset:2560 sc1
    buffer_load_dword v104, v1, s[4:7], s24 offen offset:1024 sc1
    buffer_load_dword v105, v1, s[4:7], s24 offen offset:3072 sc1
    buffer_load_dword v106, v6, s[4:7], s24 offen offset:1024 sc1
    buffer_load_dword v107, v6, s[4:7], s24 offen offset:3072 sc1
    buffer_load_dword v108, v1, s[4:7], s25 offen offset:1024 sc1
    buffer_load_dword v109, v1, s[4:7], s25 offen offset:3072 sc1
    buffer_load_dword v110, v6, s[4:7], s25 offen offset:1024 sc1
    buffer_load_dword v111, v6, s[4:7], s25 offen offset:3072 sc1
    buffer_load_dword v112, v1, s[4:7], s26 offen offset:1024 sc1
    buffer_load_dword v113, v1, s[4:7], s26 offen offset:3072 sc1
    buffer_load_dword v114, v6, s[4:7], s26 offen offset:1024 sc1
    buffer_load_dword v115, v6, s[4:7], s26 offen offset:3072 sc1
    buffer_load_dword v116, v1, s[4:7], s27 offen offset:1024 sc1
    buffer_load_dword v117, v1, s[4:7], s27 offen offset:3072 sc1
    buffer_load_dword v118, v6, s[4:7], s27 offen offset:1024 sc1
    buffer_load_dword v119, v6, s[4:7], s27 offen offset:3072 sc1
    buffer_load_dword v120, v1, s[4:7], s24 offen offset:1536 sc1
    buffer_load_dword v121, v1, s[4:7], s24 offen offset:3584 sc1
    buffer_load_dword v122, v6, s[4:7], s24 offen offset:1536 sc1
    buffer_load_dword v123, v6, s[4:7], s24 offen offset:3584 sc1
    buffer_load_dword v124, v1, s[4:7], s25 offen offset:1536 sc1
    buffer_load_dword v125, v1, s[4:7], s25 offen offset:3584 sc1
    buffer_load_dword v126, v6, s[4:7], s25 offen offset:1536 sc1
    buffer_load_dword v127, v6, s[4:7], s25 offen offset:3584 sc1
    buffer_load_dword v128, v1, s[4:7], s26 offen offset:1536 sc1
    buffer_load_dword v129, v1, s[4:7], s26 offen offset:3584 sc1
    buffer_load_dword v130, v6, s[4:7], s26 offen offset:1536 sc1
    buffer_load_dword v131, v6, s[4:7], s26 offen offset:3584 sc1
    buffer_load_dword v132, v1, s[4:7], s27 offen offset:1536 sc1
    buffer_load_dword v133, v1, s[4:7], s27 offen offset:3584 sc1
    buffer_load_dword v134, v6, s[4:7], s27 offen offset:1536 sc1
    buffer_load_dword v135, v6, s[4:7], s27 offen offset:3584 sc1
    s_add_u32 s38, s38, 1
    s_waitcnt vmcnt(0)
    v_max3_u32 v70, v72, v73, v74
    v_max3_u32 v70, v70, v75, v76
    v_max3_u32 v70, v70, v77, v78
    v_max3_u32 v70, v70, v79, v80
    v_max3_u32 v70, v70, v81, v82
    v_max3_u32 v70, v70, v83, v84
    v_max3_u32 v70, v70, v85, v86
    v_max3_u32 v70, v70, v87, v88
    v_max3_u32 v70, v70, v89, v90
    v_max3_u32 v70, v70, v91, v92
    v_max3_u32 v70, v70, v93, v94
    v_max3_u32 v70, v70, v95, v96
    v_max3_u32 v70, v70, v97, v98
    v_max3_u32 v70, v70, v99, v100
    v_max3_u32 v70, v70, v101, v102
    v_max3_u32 v70, v70, v103, v104
    v_max3_u32 v70, v70, v105, v106
    v_max3_u32 v70, v70, v107, v108
    v_max3_u32 v70, v70, v109, v110
    v_max3_u32 v70, v70, v111, v112
    v_max3_u32 v70, v70, v113, v114
    v_max3_u32 v70, v70, v115, v116
    v_max3_u32 v70, v70, v117, v118
    v_max3_u32 v70, v70, v119, v120
    v_max3_u32 v70, v70, v121, v122
    v_max3_u32 v70, v70, v123, v124
    v_max3_u32 v70, v70, v125, v126
    v_max3_u32 v70, v70, v127, v128
    v_max3_u32 v70, v70, v129, v130
    v_max3_u32 v70, v70, v131, v132
    v_max3_u32 v70, v70, v133, v134
    v_max_u32 v70, v70, v135
    v_cmp_eq_u32 vcc, -1, v70
    s_cmp_gt_u32 s38, 0x40000
    s_cbranch_scc1 GD33
    s_nop 2
    s_cmp_eq_u64 vcc, 0
    s_cbranch_scc1 GD33
    s_sleep 1
    s_branch GA32
GD33:
    v_add_f32 v72, v72, v76
    v_add_f32 v80, v80, v84
    v_add_f32 v72, v72, v80
    v_add_f32 v73, v73, v77
    v_add_f32 v81, v81, v85
    v_add_f32 v73, v73, v81
    v_add_f32 v74, v74, v78
    v_add_f32 v82, v82, v86
    v_add_f32 v74, v74, v82
    v_add_f32 v75, v75, v79
    v_add_f32 v83, v83, v87
    v_add_f32 v75, v75, v83
    v_cvt_pk_bf16_f32 v20, v72, v73
    v_lshlrev_b32 v72, 16, v20
    v_and_b32 v73, 0xffff0000, v20
    v_cvt_pk_bf16_f32 v20, v74, v75
    v_lshlrev_b32 v74, 16, v20
    v_and_b32 v75, 0xffff0000, v20
    v_add_f32 v74, 1.0, v74
    v_cvt_pk_bf16_f32 v74, v74, v74
    v_lshlrev_b32 v74, 16, v74
    v_lshlrev_b32 v7, 2, v1
    v_add_u32 v7, 81920, v7
    ds_write_b128 v7, v[72:75]
    v_add_f32 v88, v88, v92
    v_add_f32 v96, v96, v100
    v_add_f32 v88, v88, v96
    v_add_f32 v89, v89, v93
    v_add_f32 v97, v97, v101
    v_add_f32 v89, v89, v97
    v_add_f32 v90, v90, v94
    v_add_f32 v98, v98, v102
    v_add_f32 v90, v90, v98
    v_add_f32 v91, v91, v95
    v_add_f32 v99, v99, v103
    v_add_f32 v91, v91, v99
    v_cvt_pk_bf16_f32 v20, v88, v89
    v_lshlrev_b32 v88, 16, v20
    v_and_b32 v89, 0xffff0000, v20
    v_cvt_pk_bf16_f32 v20, v90, v91
    v_lshlrev_b32 v90, 16, v20
    v_and_b32 v91, 0xffff0000, v20
    v_add_f32 v90, 1.0, v90
    v_cvt_pk_bf16_f32 v90, v90, v90
    v_lshlrev_b32 v90, 16, v90
    v_lshlrev_b32 v7, 2, v1
    v_add_u32 v7, 83968, v7
    ds_write_b128 v7, v[88:91]
    v_add_f32 v104, v104, v108
    v_add_f32 v112, v112, v116
    v_add_f32 v104, v104, v112
    v_add_f32 v105, v105, v109
    v_add_f32 v113, v113, v117
    v_add_f32 v105, v105, v113
    v_add_f32 v106, v106, v110
    v_add_f32 v114, v114, v118
    v_add_f32 v106, v106, v114
    v_add_f32 v107, v107, v111
    v_add_f32 v115, v115, v119
    v_add_f32 v107, v107, v115
    v_cvt_pk_bf16_f32 v20, v104, v105
    v_lshlrev_b32 v104, 16, v20
    v_and_b32 v105, 0xffff0000, v20
    v_cvt_pk_bf16_f32 v20, v106, v107
    v_lshlrev_b32 v106, 16, v20
    v_and_b32 v107, 0xffff0000, v20
    v_add_f32 v106, 1.0, v106
    v_cvt_pk_bf16_f32 v106, v106, v106
    v_lshlrev_b32 v106, 16, v106
    v_lshlrev_b32 v7, 2, v1
    v_add_u32 v7, 86016, v7
    ds_write_b128 v7, v[104:107]
    v_add_f32 v120, v120, v124
    v_add_f32 v128, v128, v132
    v_add_f32 v120, v120, v128
    v_add_f32 v121, v121, v125
    v_add_f32 v129, v129, v133
    v_add_f32 v121, v121, v129
    v_add_f32 v122, v122, v126
    v_add_f32 v130, v130, v134
    v_add_f32 v122, v122, v130
    v_add_f32 v123, v123, v127
    v_add_f32 v131, v131, v135
    v_add_f32 v123, v123, v131
    v_cvt_pk_bf16_f32 v20, v120, v121
    v_lshlrev_b32 v120, 16, v20
    v_and_b32 v121, 0xffff0000, v20
    v_cvt_pk_bf16_f32 v20, v122, v123
    v_lshlrev_b32 v122, 16, v20
    v_and_b32 v123, 0xffff0000, v20
    v_add_f32 v122, 1.0, v122
    v_cvt_pk_bf16_f32 v122, v122, v122
    v_lshlrev_b32 v122, 16, v122
    v_lshlrev_b32 v7, 2, v1
    v_add_u32 v7, 88064, v7
    ds_write_b128 v7, v[120:123]
    s_waitcnt lgkmcnt(0)
X_MGD:
    s_waitcnt vmcnt(0)
    s_barrier
    s_barrier
    s_barrier
    ds_read_b32 v8, v1 offset:4096
    ds_read_b32 v9, v1 offset:4608
    ds_read_b32 v10, v1 offset:5120
    ds_read_b32 v11, v1 offset:5632
    ds_read_b32 v12, v1 offset:6144
    ds_read_b32 v13, v1 offset:6656
    ds_read_b32 v14, v1 offset:7168
    ds_read_b32 v15, v1 offset:7680
    s_waitcnt lgkmcnt(0)
    v_add_f32 v8, v8, v9
    v_add_f32 v10, v10, v11
    v_add_f32 v12, v12, v13
    v_add_f32 v14, v14, v15
    v_add_f32 v8, v8, v10
    v_add_f32 v12, v12, v14
    v_add_f32 v8, v8, v12
    s_lshl_b32 s3, s2, 9
    s_add_u32 s3, s3, 262144
    buffer_store_dword v8, v1, s[4:7], s3 offen sc1
    s_barrier
    s_barrier
    s_cmp_lg_u32 s39, 8
    s_cbranch_scc1 X_END
    v_cmp_gt_u32 vcc, 16, v0
    s_and_saveexec_b64 s[36:37], vcc
    ds_read_b32 v8, v1 offset:12288
    ds_read_b32 v9, v1 offset:12352
    ds_read_b32 v10, v1 offset:12416
    ds_read_b32 v11, v1 offset:12480
    ds_read_b32 v12, v1 offset:12544
    ds_read_b32 v13, v1 offset:12608
    ds_read_b32 v14, v1 offset:12672
    ds_read_b32 v15, v1 offset:12736
    s_waitcnt lgkmcnt(0)
    v_add_f32 v8, v8, v9
    v_add_f32 v10, v10, v11
    v_add_f32 v12, v12, v13
    v_add_f32 v14, v14, v15
    v_add_f32 v8, v8, v10
    v_add_f32 v12, v12, v14
    v_add_f32 v8, v8, v12
    s_lshr_b32 s3, s2, 5
    s_lshl_b32 s3, s3, 11
    s_and_b32 s28, s2, 7
    s_lshl_b32 s28, s28, 8
    s_add_u32 s3, s3, s28
    s_bfe_u32 s28, s2, 0x20003
    s_lshl_b32 s28, s28, 6
    s_add_u32 s3, s3, s28
    s_add_u32 s3, s3, 393216
    buffer_store_dword v8, v1, s[4:7], s3 offen sc1
X_END:
K_END:
    s_endpgm
.section .rodata,"a"
.p2align 6
.amdhsa_kernel adaLN_cond__compressed_kv_cla__mixer_channel_mlp__decode_kernel
  .amdhsa_next_free_vgpr 160
  .amdhsa_next_free_sgpr 102
  .amdhsa_accum_offset 160
  .amdhsa_group_segment_fixed_size 0
  .amdhsa_kernarg_size 128
  .amdhsa_user_sgpr_count 2
  .amdhsa_user_sgpr_kernarg_segment_ptr 1
  .amdhsa_system_sgpr_workgroup_id_x 1
.end_amdhsa_kernel
```
